```python
import torch

def _softmax(x, axis=-1):
    return torch.softmax(x, dim=axis)
def _gelu(x):
    return torch.nn.functional.gelu(x, approximate="tanh")
def _silu(x):
    return torch.nn.functional.silu(x)
def _sigmoid(x):
    return torch.sigmoid(x)
def _layernorm(x, axis=-1, eps=1e-5):
    m = x.mean(dim=axis, keepdim=True)
    v = x.var(dim=axis, keepdim=True, unbiased=False)
    return (x - m) / torch.sqrt(v + eps)
def _scatter_add(tgt, idx, src, axis=0):
    return tgt.clone().index_add_(axis, idx, src)
def _segment_sum(src, seg, n):
    out = torch.zeros((n,) + src.shape[1:], dtype=src.dtype)
    return out.index_add_(0, seg, src)
def _pad(x, pw):
    flat = tuple(v for pair in reversed(pw) for v in pair)
    return torch.nn.functional.pad(x, flat)

kernel_name = 'sequential_preLN__sliding_block__geglu_ffn__prompt'

def setup_inputs():

    _w = (lambda a: (lambda t: t.to(torch.bfloat16) if t.is_floating_point() else t)(torch.as_tensor(a)))
    def _A_setup():
        B, S, D = 1, 2048, 512
        return {
            "x": _w((lambda *s: torch.randn(*s, dtype=torch.bfloat16) * 0.05)(B, S, D)),
            "wqkv": _w((lambda *s: torch.randn(*s, dtype=torch.bfloat16) * 0.05)(D, 3 * D)),
            "wo": _w((lambda *s: torch.randn(*s, dtype=torch.bfloat16) * 0.05)(D, D)),
        }
    _A_in = _A_setup()

    def _B_setup():
        B, S, D, F = 1, 2048, 512, 1792
        return {
            "x": _w((lambda *s: torch.randn(*s, dtype=torch.bfloat16) * 0.05)(B, S, D)),
            "w_gate": _w((lambda *s: torch.randn(*s, dtype=torch.bfloat16) * 0.05)(D, F)),
            "w_up": _w((lambda *s: torch.randn(*s, dtype=torch.bfloat16) * 0.05)(D, F)),
            "w_down": _w((lambda *s: torch.randn(*s, dtype=torch.bfloat16) * 0.05)(F, D)),
        }
    _B_in = _B_setup()

    return {
        "A_x": _A_in["x"],
        "A_wqkv": _A_in["wqkv"],
        "A_wo": _A_in["wo"],
        "B_x": _B_in["x"],
        "B_w_gate": _B_in["w_gate"],
        "B_w_up": _B_in["w_up"],
        "B_w_down": _B_in["w_down"],
    }

def reference(A_x, A_wqkv, A_wo, B_x, B_w_gate, B_w_up, B_w_down):
    def _A_ref(x, wqkv, wo):
        B, S, D = x.shape
        H = 32; Dh = D // H; W = 256
        qkv = (lambda x, *d: x.permute(*d))((x @ wqkv).reshape(B, S, 3, H, Dh), 2, 0, 3, 1, 4)
        q, k, v = qkv[0], qkv[1], qkv[2]
        scores = torch.einsum("bhqd,bhkd->bhqk", q, k) * (Dh ** -0.5)
        idx = torch.arange(S)
        mask = (idx[:, None] - idx[None, :] >= 0) & (idx[:, None] - idx[None, :] < W)
        scores = torch.where(mask[None, None], scores, -1e9)
        p = _softmax(scores, axis=-1)
        o = torch.einsum("bhqk,bhkd->bhqd", p, v)
        return (lambda x, *d: x.permute(*d))(o, 0, 2, 1, 3).reshape(B, S, D) @ wo

    def _B_ref(x, w_gate, w_up, w_down):
        return (_gelu(x @ w_gate) * (x @ w_up)) @ w_down

    x = A_x
    h = x + _A_ref(_layernorm(x, axis=-1), A_wqkv, A_wo)
    h2 = h + _B_ref(_layernorm(h, axis=-1), B_w_gate, B_w_up, B_w_down)
    return h2
```

```asm
; @launch grid=(256,1,1) block=(512,1,1) lds=163840
.amdgcn_target "amdgcn-amd-amdhsa--gfx950"
.text
L_code_begin:
.globl sequential_preLN__sliding_block__geglu_ffn__prompt_kernel
.p2align 8
.type sequential_preLN__sliding_block__geglu_ffn__prompt_kernel,@function
sequential_preLN__sliding_block__geglu_ffn__prompt_kernel:
  s_load_dwordx16 s[16:31], s[0:1], 0
  s_load_dwordx4 s[32:35], s[0:1], 64
  s_cmp_ge_u32 s2, 256
  s_cbranch_scc1 L_end_sequential_preLN__sliding_block__geglu_ffn__prompt_kernel
  v_and_b32 v1, 63, v0
  v_lshrrev_b32 v2, 6, v0
  s_and_b32 s60, s2, 7
  s_lshr_b32 s39, s2, 3
  v_readfirstlane_b32 s36, v2
  s_lshr_b32 s37, s60, 1
  s_and_b32 s38, s60, 1
  v_lshlrev_b32 v2, 4, v1
  s_and_b32 s57, s36, 3
  s_waitcnt lgkmcnt(0)
  s_mov_b32 s48, s34
  s_and_b32 s49, s35, 0xffff
  s_mov_b32 s50, 0x1380000
  s_mov_b32 s51, 0x20000
  s_and_b32 s64, s39, 7
  s_lshl_b32 s62, s37, 3
  s_add_u32 s62, s62, s64
  s_lshr_b32 s64, s39, 3
  s_lshl_b32 s63, s38, 2
  s_add_u32 s63, s63, s64
  s_mov_b32 s40, s16
  s_and_b32 s41, s17, 0xffff
  s_mov_b32 s42, 0x200000
  s_mov_b32 s43, 0x20000
  s_mov_b32 s44, s18
  s_and_b32 s45, s19, 0xffff
  s_mov_b32 s46, 0x180000
  s_mov_b32 s47, 0x20000
  v_lshrrev_b32 v5, 3, v1
  v_lshlrev_b32 v6, 10, v5
  v_and_b32 v7, 7, v1
  v_lshlrev_b32 v7, 4, v7
  v_add_u32 v3, v6, v7
  s_lshl_b32 s64, s62, 16
  s_lshl_b32 s65, s36, 13
  s_add_u32 s64, s64, s65
  s_and_b32 s68, s63, 3
  s_lshl_b32 s68, s68, 1
  s_add_u32 s65, s68, 0
  s_and_b32 s65, s65, 7
  s_lshl_b32 s65, s65, 7
  s_add_u32 s65, s65, s64
  buffer_load_dwordx4 v[32:35], v3, s[40:43], s65 offen
  s_add_u32 s65, s68, 1
  s_and_b32 s65, s65, 7
  s_lshl_b32 s65, s65, 7
  s_add_u32 s65, s65, s64
  buffer_load_dwordx4 v[36:39], v3, s[40:43], s65 offen
  s_add_u32 s65, s68, 2
  s_and_b32 s65, s65, 7
  s_lshl_b32 s65, s65, 7
  s_add_u32 s65, s65, s64
  buffer_load_dwordx4 v[40:43], v3, s[40:43], s65 offen
  s_add_u32 s65, s68, 3
  s_and_b32 s65, s65, 7
  s_lshl_b32 s65, s65, 7
  s_add_u32 s65, s65, s64
  buffer_load_dwordx4 v[44:47], v3, s[40:43], s65 offen
  s_add_u32 s65, s68, 4
  s_and_b32 s65, s65, 7
  s_lshl_b32 s65, s65, 7
  s_add_u32 s65, s65, s64
  buffer_load_dwordx4 v[48:51], v3, s[40:43], s65 offen
  s_add_u32 s65, s68, 5
  s_and_b32 s65, s65, 7
  s_lshl_b32 s65, s65, 7
  s_add_u32 s65, s65, s64
  buffer_load_dwordx4 v[52:55], v3, s[40:43], s65 offen
  s_add_u32 s65, s68, 6
  s_and_b32 s65, s65, 7
  s_lshl_b32 s65, s65, 7
  s_add_u32 s65, s65, s64
  buffer_load_dwordx4 v[56:59], v3, s[40:43], s65 offen
  s_add_u32 s65, s68, 7
  s_and_b32 s65, s65, 7
  s_lshl_b32 s65, s65, 7
  s_add_u32 s65, s65, s64
  buffer_load_dwordx4 v[60:63], v3, s[40:43], s65 offen
  s_cmp_gt_u32 s36, 1
  s_cbranch_scc1 L_ecode
  s_getpc_b64 s[10:11]
L_ecpc:
  s_sub_u32 s10, s10, L_ecpc-L_code_begin
  s_subb_u32 s11, s11, 0
  s_lshl_b32 s12, s39, 4
  s_mul_i32 s12, s12, s36
  v_and_b32 v3, 15, v1
  s_cmp_eq_u32 s36, 0
  s_cselect_b64 s[14:15], -1, 0
  v_cndmask_b32 v3, v3, v1, s[14:15]
  v_add_u32 v3, s12, v3
  v_lshlrev_b32 v3, 7, v3
  s_mov_b32 s12, L_code_end-L_code_begin-4
  v_min_u32 v3, s12, v3
  global_load_dword v251, v3, s[10:11]
  s_nop 1
L_ecode:
  s_mov_b32 s13, s62
  s_mov_b32 s3, s63
  s_or_b32 s60, s2, s36
  s_cmp_lg_u32 s60, 0
  s_cbranch_scc1 L_epub
  s_memrealtime s[62:63]
  s_mov_b32 s52, s32
  s_and_b32 s53, s33, 0xffff
  s_mov_b32 s54, 0x100
  s_mov_b32 s55, 0x20000
  s_waitcnt lgkmcnt(0)
  s_or_b32 s62, s62, 1
  v_mov_b32 v4, s62
  v_mov_b32 v5, 0
  s_mov_b64 exec, 1
  buffer_store_dword v4, v5, s[52:55], 0 offen sc1
  s_mov_b64 exec, -1
L_epub:
  s_cmp_lg_u32 s36, 7
  s_cbranch_scc1 L_tlbw
  v_lshlrev_b32 v4, 16, v1
  s_cmp_lg_u32 s39, 0
  s_nop 1
  s_cbranch_scc1 L_tlbw0
  s_mov_b32 s52, s34
  s_and_b32 s53, s35, 0xffff
  s_mov_b32 s54, 0x1380000
  s_mov_b32 s55, 0x20000
  s_mov_b32 s60, 0
  buffer_load_dword v250, v4, s[52:55], s60 offen sc1
  s_add_u32 s60, s60, 4194304
  buffer_load_dword v250, v4, s[52:55], s60 offen sc1
  s_add_u32 s60, s60, 4194304
  buffer_load_dword v250, v4, s[52:55], s60 offen sc1
  s_add_u32 s60, s60, 4194304
  buffer_load_dword v250, v4, s[52:55], s60 offen sc1
  s_add_u32 s60, s60, 4194304
  buffer_load_dword v250, v4, s[52:55], s60 offen sc1
  s_add_u32 s60, s60, 4194304
L_tlbw0:
  s_cmp_lg_u32 s39, 1
  s_cbranch_scc1 L_tlbw1
  s_mov_b32 s52, s24
  s_and_b32 s53, s25, 0xffff
  s_mov_b32 s54, 0x1c0000
  s_mov_b32 s55, 0x20000
  s_mov_b32 s60, 0
  buffer_load_dword v250, v4, s[52:55], s60 offen sc1
  s_add_u32 s60, s60, 4194304
L_tlbw1:
  s_cmp_lg_u32 s39, 2
  s_cbranch_scc1 L_tlbw2
  s_mov_b32 s52, s26
  s_and_b32 s53, s27, 0xffff
  s_mov_b32 s54, 0x1c0000
  s_mov_b32 s55, 0x20000
  s_mov_b32 s60, 0
  buffer_load_dword v250, v4, s[52:55], s60 offen sc1
  s_add_u32 s60, s60, 4194304
L_tlbw2:
  s_cmp_lg_u32 s39, 3
  s_cbranch_scc1 L_tlbw3
  s_mov_b32 s52, s28
  s_and_b32 s53, s29, 0xffff
  s_mov_b32 s54, 0x1c0000
  s_mov_b32 s55, 0x20000
  s_mov_b32 s60, 0
  buffer_load_dword v250, v4, s[52:55], s60 offen sc1
  s_add_u32 s60, s60, 4194304
L_tlbw3:
  s_cmp_lg_u32 s39, 4
  s_cbranch_scc1 L_tlbw4
  s_mov_b32 s52, s30
  s_and_b32 s53, s31, 0xffff
  s_mov_b32 s54, 0x200000
  s_mov_b32 s55, 0x20000
  s_mov_b32 s60, 0
  buffer_load_dword v250, v4, s[52:55], s60 offen sc1
  s_add_u32 s60, s60, 4194304
L_tlbw4:
  s_cmp_lg_u32 s39, 5
  s_cbranch_scc1 L_tlbw5
  s_mov_b32 s52, s20
  s_and_b32 s53, s21, 0xffff
  s_mov_b32 s54, 0x80000
  s_mov_b32 s55, 0x20000
  s_mov_b32 s60, 0
  buffer_load_dword v250, v4, s[52:55], s60 offen sc1
  s_add_u32 s60, s60, 4194304
L_tlbw5:
L_tlbw:
  s_mov_b32 s62, s13
  s_mov_b32 s63, s3
  v_lshrrev_b32 v5, 3, v1
  v_and_b32 v7, 7, v1
  v_lshlrev_b32 v7, 4, v7
  s_lshl_b32 s64, s36, 3
  v_add_u32 v5, s64, v5
  s_mov_b32 s64, 1040
  v_mul_lo_u32 v8, v5, s64
  v_add_u32 v8, v8, v7
  v_lshrrev_b32 v5, 3, v1
  v_and_b32 v6, 7, v1
  v_lshlrev_b32 v7, 1, v5
  v_and_b32 v7, 4, v7
  v_xor_b32 v6, v6, v7
  v_lshlrev_b32 v6, 4, v6
  s_mov_b32 s61, 3072
  v_mul_lo_u32 v4, v5, s61
  v_add_u32 v4, v4, v6
  s_lshl_b32 s66, s63, 7
  s_mul_i32 s64, s57, 24576
  s_add_u32 s66, s66, s64
  s_lshl_b32 s67, s57, 10
  s_add_u32 s67, s67, 66560
  s_cmp_lt_u32 s36, 4
  s_cbranch_scc1 L_p1_nodma
  s_add_u32 s64, s66, 0
  s_mov_b32 m0, s67
  s_nop 0
  buffer_load_dwordx4 v4, s[44:47], s64 offen lds
  s_add_u32 s64, s66, 1024
  s_add_u32 m0, s67, 4096
  s_nop 0
  buffer_load_dwordx4 v4, s[44:47], s64 offen lds
  s_add_u32 s64, s66, 2048
  s_add_u32 m0, s67, 8192
  s_nop 0
  buffer_load_dwordx4 v4, s[44:47], s64 offen lds
  s_add_u32 s64, s66, 98304
  s_add_u32 m0, s67, 12288
  s_nop 0
  buffer_load_dwordx4 v4, s[44:47], s64 offen lds
  s_add_u32 s64, s66, 99328
  s_add_u32 m0, s67, 16384
  s_nop 0
  buffer_load_dwordx4 v4, s[44:47], s64 offen lds
  s_add_u32 s64, s66, 100352
  s_add_u32 m0, s67, 20480
  s_nop 0
  buffer_load_dwordx4 v4, s[44:47], s64 offen lds
  s_mov_b32 s52, s18
  s_and_b32 s53, s19, 0xffff
  s_mov_b32 s54, 0x180000
  s_mov_b32 s55, 0x20000
  v_lshrrev_b32 v26, 2, v1
  s_mov_b32 s74, 3072
  v_mul_lo_u32 v26, v26, s74
  v_and_b32 v27, 3, v1
  v_lshlrev_b32 v27, 7, v27
  v_add_u32 v26, v26, v27
  s_mul_i32 s74, s39, 49152
  s_lshl_b32 s75, s38, 9
  s_add_u32 s74, s74, s75
  s_min_u32 s75, s57, 2
  s_lshl_b32 s75, s75, 10
  s_add_u32 s74, s74, s75
  buffer_load_dword v30, v26, s[52:55], s74 offen
  s_waitcnt vmcnt(7)
  s_branch L_p1_ln
L_p1_nodma:
  s_waitcnt vmcnt(0)
L_p1_ln:
  v_mov_b32 v20, 0x3f803f80
  v_mov_b32 v12, 0
  v_mov_b32 v16, 0
  v_mov_b32 v13, 0
  v_mov_b32 v17, 0
  v_mov_b32 v14, 0
  v_mov_b32 v18, 0
  v_mov_b32 v15, 0
  v_mov_b32 v19, 0
  v_dot2_f32_bf16 v12, v32, v20, v12
  v_dot2_f32_bf16 v16, v32, v32, v16
  v_dot2_f32_bf16 v13, v33, v20, v13
  v_dot2_f32_bf16 v17, v33, v33, v17
  v_dot2_f32_bf16 v14, v34, v20, v14
  v_dot2_f32_bf16 v18, v34, v34, v18
  v_dot2_f32_bf16 v15, v35, v20, v15
  v_dot2_f32_bf16 v19, v35, v35, v19
  v_dot2_f32_bf16 v12, v36, v20, v12
  v_dot2_f32_bf16 v16, v36, v36, v16
  v_dot2_f32_bf16 v13, v37, v20, v13
  v_dot2_f32_bf16 v17, v37, v37, v17
  v_dot2_f32_bf16 v14, v38, v20, v14
  v_dot2_f32_bf16 v18, v38, v38, v18
  v_dot2_f32_bf16 v15, v39, v20, v15
  v_dot2_f32_bf16 v19, v39, v39, v19
  v_dot2_f32_bf16 v12, v40, v20, v12
  v_dot2_f32_bf16 v16, v40, v40, v16
  v_dot2_f32_bf16 v13, v41, v20, v13
  v_dot2_f32_bf16 v17, v41, v41, v17
  v_dot2_f32_bf16 v14, v42, v20, v14
  v_dot2_f32_bf16 v18, v42, v42, v18
  v_dot2_f32_bf16 v15, v43, v20, v15
  v_dot2_f32_bf16 v19, v43, v43, v19
  v_dot2_f32_bf16 v12, v44, v20, v12
  v_dot2_f32_bf16 v16, v44, v44, v16
  v_dot2_f32_bf16 v13, v45, v20, v13
  v_dot2_f32_bf16 v17, v45, v45, v17
  v_dot2_f32_bf16 v14, v46, v20, v14
  v_dot2_f32_bf16 v18, v46, v46, v18
  v_dot2_f32_bf16 v15, v47, v20, v15
  v_dot2_f32_bf16 v19, v47, v47, v19
  v_dot2_f32_bf16 v12, v48, v20, v12
  v_dot2_f32_bf16 v16, v48, v48, v16
  v_dot2_f32_bf16 v13, v49, v20, v13
  v_dot2_f32_bf16 v17, v49, v49, v17
  v_dot2_f32_bf16 v14, v50, v20, v14
  v_dot2_f32_bf16 v18, v50, v50, v18
  v_dot2_f32_bf16 v15, v51, v20, v15
  v_dot2_f32_bf16 v19, v51, v51, v19
  v_dot2_f32_bf16 v12, v52, v20, v12
  v_dot2_f32_bf16 v16, v52, v52, v16
  v_dot2_f32_bf16 v13, v53, v20, v13
  v_dot2_f32_bf16 v17, v53, v53, v17
  v_dot2_f32_bf16 v14, v54, v20, v14
  v_dot2_f32_bf16 v18, v54, v54, v18
  v_dot2_f32_bf16 v15, v55, v20, v15
  v_dot2_f32_bf16 v19, v55, v55, v19
  v_dot2_f32_bf16 v12, v56, v20, v12
  v_dot2_f32_bf16 v16, v56, v56, v16
  v_dot2_f32_bf16 v13, v57, v20, v13
  v_dot2_f32_bf16 v17, v57, v57, v17
  v_dot2_f32_bf16 v14, v58, v20, v14
  v_dot2_f32_bf16 v18, v58, v58, v18
  v_dot2_f32_bf16 v15, v59, v20, v15
  v_dot2_f32_bf16 v19, v59, v59, v19
  v_dot2_f32_bf16 v12, v60, v20, v12
  v_dot2_f32_bf16 v16, v60, v60, v16
  v_dot2_f32_bf16 v13, v61, v20, v13
  v_dot2_f32_bf16 v17, v61, v61, v17
  v_dot2_f32_bf16 v14, v62, v20, v14
  v_dot2_f32_bf16 v18, v62, v62, v18
  v_dot2_f32_bf16 v15, v63, v20, v15
  v_dot2_f32_bf16 v19, v63, v63, v19
  v_add_f32 v12, v12, v13
  v_add_f32 v16, v16, v17
  v_add_f32 v14, v14, v15
  v_add_f32 v18, v18, v19
  v_add_f32 v12, v12, v14
  v_add_f32 v16, v16, v18
  s_nop 0
  v_add_f32_dpp v12, v12, v12 quad_perm:[1,0,3,2] row_mask:0xf bank_mask:0xf
  v_add_f32_dpp v16, v16, v16 quad_perm:[1,0,3,2] row_mask:0xf bank_mask:0xf
  s_nop 0
  v_add_f32_dpp v12, v12, v12 quad_perm:[2,3,0,1] row_mask:0xf bank_mask:0xf
  v_add_f32_dpp v16, v16, v16 quad_perm:[2,3,0,1] row_mask:0xf bank_mask:0xf
  s_nop 0
  v_add_f32_dpp v12, v12, v12 row_half_mirror row_mask:0xf bank_mask:0xf
  v_add_f32_dpp v16, v16, v16 row_half_mirror row_mask:0xf bank_mask:0xf
  v_mul_f32 v12, 0x3b000000, v12
  v_mul_f32 v16, 0x3b000000, v16
  v_fma_f32 v16, -v12, v12, v16
  v_max_f32 v16, 0, v16
  v_add_f32 v16, 0x3727c5ac, v16
  v_rsq_f32 v22, v16
  s_nop 0
  v_mul_f32 v24, v12, v22
  v_sub_f32 v24, 0, v24
  v_lshlrev_b32 v64, 16, v32
  v_and_b32 v65, 0xffff0000, v32
  v_lshlrev_b32 v66, 16, v33
  v_and_b32 v67, 0xffff0000, v33
  v_lshlrev_b32 v68, 16, v34
  v_and_b32 v69, 0xffff0000, v34
  v_lshlrev_b32 v70, 16, v35
  v_and_b32 v71, 0xffff0000, v35
  v_pk_fma_f32 v[64:65], v[64:65], v[22:23], v[24:25] op_sel_hi:[1,0,0]
  v_pk_fma_f32 v[66:67], v[66:67], v[22:23], v[24:25] op_sel_hi:[1,0,0]
  v_pk_fma_f32 v[68:69], v[68:69], v[22:23], v[24:25] op_sel_hi:[1,0,0]
  v_pk_fma_f32 v[70:71], v[70:71], v[22:23], v[24:25] op_sel_hi:[1,0,0]
  v_cvt_pk_bf16_f32 v32, v64, v65
  v_cvt_pk_bf16_f32 v33, v66, v67
  v_cvt_pk_bf16_f32 v34, v68, v69
  v_cvt_pk_bf16_f32 v35, v70, v71
  s_add_u32 s65, s68, 0
  s_and_b32 s65, s65, 7
  s_lshl_b32 s65, s65, 7
  v_add_u32 v5, s65, v8
  ds_write_b128 v5, v[32:35] offset:0
  v_lshlrev_b32 v72, 16, v36
  v_and_b32 v73, 0xffff0000, v36
  v_lshlrev_b32 v74, 16, v37
  v_and_b32 v75, 0xffff0000, v37
  v_lshlrev_b32 v76, 16, v38
  v_and_b32 v77, 0xffff0000, v38
  v_lshlrev_b32 v78, 16, v39
  v_and_b32 v79, 0xffff0000, v39
  v_pk_fma_f32 v[72:73], v[72:73], v[22:23], v[24:25] op_sel_hi:[1,0,0]
  v_pk_fma_f32 v[74:75], v[74:75], v[22:23], v[24:25] op_sel_hi:[1,0,0]
  v_pk_fma_f32 v[76:77], v[76:77], v[22:23], v[24:25] op_sel_hi:[1,0,0]
  v_pk_fma_f32 v[78:79], v[78:79], v[22:23], v[24:25] op_sel_hi:[1,0,0]
  v_cvt_pk_bf16_f32 v36, v72, v73
  v_cvt_pk_bf16_f32 v37, v74, v75
  v_cvt_pk_bf16_f32 v38, v76, v77
  v_cvt_pk_bf16_f32 v39, v78, v79
  s_add_u32 s65, s68, 1
  s_and_b32 s65, s65, 7
  s_lshl_b32 s65, s65, 7
  v_add_u32 v6, s65, v8
  ds_write_b128 v6, v[36:39] offset:0
  v_lshlrev_b32 v64, 16, v40
  v_and_b32 v65, 0xffff0000, v40
  v_lshlrev_b32 v66, 16, v41
  v_and_b32 v67, 0xffff0000, v41
  v_lshlrev_b32 v68, 16, v42
  v_and_b32 v69, 0xffff0000, v42
  v_lshlrev_b32 v70, 16, v43
  v_and_b32 v71, 0xffff0000, v43
  v_pk_fma_f32 v[64:65], v[64:65], v[22:23], v[24:25] op_sel_hi:[1,0,0]
  v_pk_fma_f32 v[66:67], v[66:67], v[22:23], v[24:25] op_sel_hi:[1,0,0]
  v_pk_fma_f32 v[68:69], v[68:69], v[22:23], v[24:25] op_sel_hi:[1,0,0]
  v_pk_fma_f32 v[70:71], v[70:71], v[22:23], v[24:25] op_sel_hi:[1,0,0]
  v_cvt_pk_bf16_f32 v40, v64, v65
  v_cvt_pk_bf16_f32 v41, v66, v67
  v_cvt_pk_bf16_f32 v42, v68, v69
  v_cvt_pk_bf16_f32 v43, v70, v71
  s_add_u32 s65, s68, 2
  s_and_b32 s65, s65, 7
  s_lshl_b32 s65, s65, 7
  v_add_u32 v5, s65, v8
  ds_write_b128 v5, v[40:43] offset:0
  v_lshlrev_b32 v72, 16, v44
  v_and_b32 v73, 0xffff0000, v44
  v_lshlrev_b32 v74, 16, v45
  v_and_b32 v75, 0xffff0000, v45
  v_lshlrev_b32 v76, 16, v46
  v_and_b32 v77, 0xffff0000, v46
  v_lshlrev_b32 v78, 16, v47
  v_and_b32 v79, 0xffff0000, v47
  v_pk_fma_f32 v[72:73], v[72:73], v[22:23], v[24:25] op_sel_hi:[1,0,0]
  v_pk_fma_f32 v[74:75], v[74:75], v[22:23], v[24:25] op_sel_hi:[1,0,0]
  v_pk_fma_f32 v[76:77], v[76:77], v[22:23], v[24:25] op_sel_hi:[1,0,0]
  v_pk_fma_f32 v[78:79], v[78:79], v[22:23], v[24:25] op_sel_hi:[1,0,0]
  v_cvt_pk_bf16_f32 v44, v72, v73
  v_cvt_pk_bf16_f32 v45, v74, v75
  v_cvt_pk_bf16_f32 v46, v76, v77
  v_cvt_pk_bf16_f32 v47, v78, v79
  s_add_u32 s65, s68, 3
  s_and_b32 s65, s65, 7
  s_lshl_b32 s65, s65, 7
  v_add_u32 v6, s65, v8
  ds_write_b128 v6, v[44:47] offset:0
  v_lshlrev_b32 v64, 16, v48
  v_and_b32 v65, 0xffff0000, v48
  v_lshlrev_b32 v66, 16, v49
  v_and_b32 v67, 0xffff0000, v49
  v_lshlrev_b32 v68, 16, v50
  v_and_b32 v69, 0xffff0000, v50
  v_lshlrev_b32 v70, 16, v51
  v_and_b32 v71, 0xffff0000, v51
  v_pk_fma_f32 v[64:65], v[64:65], v[22:23], v[24:25] op_sel_hi:[1,0,0]
  v_pk_fma_f32 v[66:67], v[66:67], v[22:23], v[24:25] op_sel_hi:[1,0,0]
  v_pk_fma_f32 v[68:69], v[68:69], v[22:23], v[24:25] op_sel_hi:[1,0,0]
  v_pk_fma_f32 v[70:71], v[70:71], v[22:23], v[24:25] op_sel_hi:[1,0,0]
  v_cvt_pk_bf16_f32 v48, v64, v65
  v_cvt_pk_bf16_f32 v49, v66, v67
  v_cvt_pk_bf16_f32 v50, v68, v69
  v_cvt_pk_bf16_f32 v51, v70, v71
  s_add_u32 s65, s68, 4
  s_and_b32 s65, s65, 7
  s_lshl_b32 s65, s65, 7
  v_add_u32 v5, s65, v8
  ds_write_b128 v5, v[48:51] offset:0
  v_lshlrev_b32 v72, 16, v52
  v_and_b32 v73, 0xffff0000, v52
  v_lshlrev_b32 v74, 16, v53
  v_and_b32 v75, 0xffff0000, v53
  v_lshlrev_b32 v76, 16, v54
  v_and_b32 v77, 0xffff0000, v54
  v_lshlrev_b32 v78, 16, v55
  v_and_b32 v79, 0xffff0000, v55
  v_pk_fma_f32 v[72:73], v[72:73], v[22:23], v[24:25] op_sel_hi:[1,0,0]
  v_pk_fma_f32 v[74:75], v[74:75], v[22:23], v[24:25] op_sel_hi:[1,0,0]
  v_pk_fma_f32 v[76:77], v[76:77], v[22:23], v[24:25] op_sel_hi:[1,0,0]
  v_pk_fma_f32 v[78:79], v[78:79], v[22:23], v[24:25] op_sel_hi:[1,0,0]
  v_cvt_pk_bf16_f32 v52, v72, v73
  v_cvt_pk_bf16_f32 v53, v74, v75
  v_cvt_pk_bf16_f32 v54, v76, v77
  v_cvt_pk_bf16_f32 v55, v78, v79
  s_add_u32 s65, s68, 5
  s_and_b32 s65, s65, 7
  s_lshl_b32 s65, s65, 7
  v_add_u32 v6, s65, v8
  ds_write_b128 v6, v[52:55] offset:0
  v_lshlrev_b32 v64, 16, v56
  v_and_b32 v65, 0xffff0000, v56
  v_lshlrev_b32 v66, 16, v57
  v_and_b32 v67, 0xffff0000, v57
  v_lshlrev_b32 v68, 16, v58
  v_and_b32 v69, 0xffff0000, v58
  v_lshlrev_b32 v70, 16, v59
  v_and_b32 v71, 0xffff0000, v59
  v_pk_fma_f32 v[64:65], v[64:65], v[22:23], v[24:25] op_sel_hi:[1,0,0]
  v_pk_fma_f32 v[66:67], v[66:67], v[22:23], v[24:25] op_sel_hi:[1,0,0]
  v_pk_fma_f32 v[68:69], v[68:69], v[22:23], v[24:25] op_sel_hi:[1,0,0]
  v_pk_fma_f32 v[70:71], v[70:71], v[22:23], v[24:25] op_sel_hi:[1,0,0]
  v_cvt_pk_bf16_f32 v56, v64, v65
  v_cvt_pk_bf16_f32 v57, v66, v67
  v_cvt_pk_bf16_f32 v58, v68, v69
  v_cvt_pk_bf16_f32 v59, v70, v71
  s_add_u32 s65, s68, 6
  s_and_b32 s65, s65, 7
  s_lshl_b32 s65, s65, 7
  v_add_u32 v5, s65, v8
  ds_write_b128 v5, v[56:59] offset:0
  v_lshlrev_b32 v72, 16, v60
  v_and_b32 v73, 0xffff0000, v60
  v_lshlrev_b32 v74, 16, v61
  v_and_b32 v75, 0xffff0000, v61
  v_lshlrev_b32 v76, 16, v62
  v_and_b32 v77, 0xffff0000, v62
  v_lshlrev_b32 v78, 16, v63
  v_and_b32 v79, 0xffff0000, v63
  v_pk_fma_f32 v[72:73], v[72:73], v[22:23], v[24:25] op_sel_hi:[1,0,0]
  v_pk_fma_f32 v[74:75], v[74:75], v[22:23], v[24:25] op_sel_hi:[1,0,0]
  v_pk_fma_f32 v[76:77], v[76:77], v[22:23], v[24:25] op_sel_hi:[1,0,0]
  v_pk_fma_f32 v[78:79], v[78:79], v[22:23], v[24:25] op_sel_hi:[1,0,0]
  v_cvt_pk_bf16_f32 v60, v72, v73
  v_cvt_pk_bf16_f32 v61, v74, v75
  v_cvt_pk_bf16_f32 v62, v76, v77
  v_cvt_pk_bf16_f32 v63, v78, v79
  s_add_u32 s65, s68, 7
  s_and_b32 s65, s65, 7
  s_lshl_b32 s65, s65, 7
  v_add_u32 v6, s65, v8
  ds_write_b128 v6, v[60:63] offset:0
  s_cmp_lt_u32 s36, 4
  s_nop 0
  s_cbranch_scc1 L_p1_main
  s_add_u32 s64, s66, 196608
  s_add_u32 m0, s67, 24576
  s_nop 0
  buffer_load_dwordx4 v4, s[44:47], s64 offen lds
  s_add_u32 s64, s66, 197632
  s_add_u32 m0, s67, 28672
  s_nop 0
  buffer_load_dwordx4 v4, s[44:47], s64 offen lds
  s_add_u32 s64, s66, 198656
  s_add_u32 m0, s67, 32768
  s_nop 0
  buffer_load_dwordx4 v4, s[44:47], s64 offen lds
  s_add_u32 s64, s66, 294912
  s_add_u32 m0, s67, 36864
  s_nop 0
  buffer_load_dwordx4 v4, s[44:47], s64 offen lds
  s_add_u32 s64, s66, 295936
  s_add_u32 m0, s67, 40960
  s_nop 0
  buffer_load_dwordx4 v4, s[44:47], s64 offen lds
  s_add_u32 s64, s66, 296960
  s_add_u32 m0, s67, 45056
  s_nop 0
  buffer_load_dwordx4 v4, s[44:47], s64 offen lds
  s_add_u32 s64, s66, 393216
  s_add_u32 m0, s67, 49152
  s_nop 0
  buffer_load_dwordx4 v4, s[44:47], s64 offen lds
  s_add_u32 s64, s66, 394240
  s_add_u32 m0, s67, 53248
  s_nop 0
  buffer_load_dwordx4 v4, s[44:47], s64 offen lds
  s_add_u32 s64, s66, 395264
  s_add_u32 m0, s67, 57344
  s_nop 0
  buffer_load_dwordx4 v4, s[44:47], s64 offen lds
  s_add_u32 s64, s66, 491520
  s_add_u32 m0, s67, 61440
  s_nop 0
  buffer_load_dwordx4 v4, s[44:47], s64 offen lds
  s_add_u32 s64, s66, 492544
  s_add_u32 m0, s67, 65536
  s_nop 0
  buffer_load_dwordx4 v4, s[44:47], s64 offen lds
  s_add_u32 s64, s66, 493568
  s_add_u32 m0, s67, 69632
  s_nop 0
  buffer_load_dwordx4 v4, s[44:47], s64 offen lds
  s_waitcnt vmcnt(16) lgkmcnt(0)
  s_barrier
  s_waitcnt vmcnt(13) lgkmcnt(0)
  s_barrier
  s_waitcnt vmcnt(9) lgkmcnt(0)
  s_barrier
  s_add_u32 s64, s66, 589824
  s_mov_b32 m0, s67
  s_nop 0
  buffer_load_dwordx4 v4, s[44:47], s64 offen lds
  s_add_u32 s64, s66, 590848
  s_add_u32 m0, s67, 4096
  s_nop 0
  buffer_load_dwordx4 v4, s[44:47], s64 offen lds
  s_add_u32 s64, s66, 591872
  s_add_u32 m0, s67, 8192
  s_nop 0
  buffer_load_dwordx4 v4, s[44:47], s64 offen lds
  s_waitcnt vmcnt(9) lgkmcnt(0)
  s_barrier
  s_add_u32 s64, s66, 688128
  s_add_u32 m0, s67, 12288
  s_nop 0
  buffer_load_dwordx4 v4, s[44:47], s64 offen lds
  s_add_u32 s64, s66, 689152
  s_add_u32 m0, s67, 16384
  s_nop 0
  buffer_load_dwordx4 v4, s[44:47], s64 offen lds
  s_add_u32 s64, s66, 690176
  s_add_u32 m0, s67, 20480
  s_nop 0
  buffer_load_dwordx4 v4, s[44:47], s64 offen lds
  s_waitcnt vmcnt(9) lgkmcnt(0)
  s_barrier
  s_add_u32 s64, s66, 786432
  s_add_u32 m0, s67, 24576
  s_nop 0
  buffer_load_dwordx4 v4, s[44:47], s64 offen lds
  s_add_u32 s64, s66, 787456
  s_add_u32 m0, s67, 28672
  s_nop 0
  buffer_load_dwordx4 v4, s[44:47], s64 offen lds
  s_add_u32 s64, s66, 788480
  s_add_u32 m0, s67, 32768
  s_nop 0
  buffer_load_dwordx4 v4, s[44:47], s64 offen lds
  s_waitcnt vmcnt(9) lgkmcnt(0)
  s_barrier
  s_add_u32 s64, s66, 884736
  s_add_u32 m0, s67, 36864
  s_nop 0
  buffer_load_dwordx4 v4, s[44:47], s64 offen lds
  s_add_u32 s64, s66, 885760
  s_add_u32 m0, s67, 40960
  s_nop 0
  buffer_load_dwordx4 v4, s[44:47], s64 offen lds
  s_add_u32 s64, s66, 886784
  s_add_u32 m0, s67, 45056
  s_nop 0
  buffer_load_dwordx4 v4, s[44:47], s64 offen lds
  s_waitcnt vmcnt(9) lgkmcnt(0)
  s_barrier
  s_add_u32 s64, s66, 983040
  s_add_u32 m0, s67, 49152
  s_nop 0
  buffer_load_dwordx4 v4, s[44:47], s64 offen lds
  s_add_u32 s64, s66, 984064
  s_add_u32 m0, s67, 53248
  s_nop 0
  buffer_load_dwordx4 v4, s[44:47], s64 offen lds
  s_add_u32 s64, s66, 985088
  s_add_u32 m0, s67, 57344
  s_nop 0
  buffer_load_dwordx4 v4, s[44:47], s64 offen lds
  s_waitcnt vmcnt(9) lgkmcnt(0)
  s_barrier
  s_add_u32 s64, s66, 1081344
  s_add_u32 m0, s67, 61440
  s_nop 0
  buffer_load_dwordx4 v4, s[44:47], s64 offen lds
  s_add_u32 s64, s66, 1082368
  s_add_u32 m0, s67, 65536
  s_nop 0
  buffer_load_dwordx4 v4, s[44:47], s64 offen lds
  s_add_u32 s64, s66, 1083392
  s_add_u32 m0, s67, 69632
  s_nop 0
  buffer_load_dwordx4 v4, s[44:47], s64 offen lds
  s_waitcnt vmcnt(9) lgkmcnt(0)
  s_barrier
  s_add_u32 s64, s66, 1179648
  s_mov_b32 m0, s67
  s_nop 0
  buffer_load_dwordx4 v4, s[44:47], s64 offen lds
  s_add_u32 s64, s66, 1180672
  s_add_u32 m0, s67, 4096
  s_nop 0
  buffer_load_dwordx4 v4, s[44:47], s64 offen lds
  s_add_u32 s64, s66, 1181696
  s_add_u32 m0, s67, 8192
  s_nop 0
  buffer_load_dwordx4 v4, s[44:47], s64 offen lds
  s_mov_b32 s52, s20
  s_and_b32 s53, s21, 0xffff
  s_mov_b32 s54, 0x80000
  s_mov_b32 s55, 0x20000
  v_lshrrev_b32 v26, 2, v1
  v_lshlrev_b32 v26, 10, v26
  v_and_b32 v27, 3, v1
  v_lshlrev_b32 v27, 7, v27
  v_add_u32 v26, v26, v27
  s_lshl_b32 s74, s39, 14
  s_lshl_b32 s75, s38, 9
  s_add_u32 s74, s74, s75
  buffer_load_dword v30, v26, s[52:55], s74 offen
  s_waitcnt vmcnt(9) lgkmcnt(0)
  s_barrier
  s_add_u32 s64, s66, 1277952
  s_add_u32 m0, s67, 12288
  s_nop 0
  buffer_load_dwordx4 v4, s[44:47], s64 offen lds
  s_add_u32 s64, s66, 1278976
  s_add_u32 m0, s67, 16384
  s_nop 0
  buffer_load_dwordx4 v4, s[44:47], s64 offen lds
  s_add_u32 s64, s66, 1280000
  s_add_u32 m0, s67, 20480
  s_nop 0
  buffer_load_dwordx4 v4, s[44:47], s64 offen lds
  s_waitcnt vmcnt(9) lgkmcnt(0)
  s_barrier
  s_add_u32 s64, s66, 1376256
  s_add_u32 m0, s67, 24576
  s_nop 0
  buffer_load_dwordx4 v4, s[44:47], s64 offen lds
  s_add_u32 s64, s66, 1377280
  s_add_u32 m0, s67, 28672
  s_nop 0
  buffer_load_dwordx4 v4, s[44:47], s64 offen lds
  s_add_u32 s64, s66, 1378304
  s_add_u32 m0, s67, 32768
  s_nop 0
  buffer_load_dwordx4 v4, s[44:47], s64 offen lds
  s_waitcnt vmcnt(9) lgkmcnt(0)
  s_barrier
  s_add_u32 s64, s66, 1474560
  s_add_u32 m0, s67, 36864
  s_nop 0
  buffer_load_dwordx4 v4, s[44:47], s64 offen lds
  s_add_u32 s64, s66, 1475584
  s_add_u32 m0, s67, 40960
  s_nop 0
  buffer_load_dwordx4 v4, s[44:47], s64 offen lds
  s_add_u32 s64, s66, 1476608
  s_add_u32 m0, s67, 45056
  s_nop 0
  buffer_load_dwordx4 v4, s[44:47], s64 offen lds
  s_waitcnt vmcnt(9) lgkmcnt(0)
  s_barrier
  s_waitcnt vmcnt(6) lgkmcnt(0)
  s_barrier
  s_waitcnt vmcnt(3) lgkmcnt(0)
  s_barrier
  s_waitcnt vmcnt(0) lgkmcnt(0)
  s_barrier
  s_mov_b32 s52, s32
  s_and_b32 s53, s33, 0xffff
  s_mov_b32 s54, 0x100
  s_mov_b32 s55, 0x20000
  v_mov_b32 v29, 0
  buffer_load_dword v28, v29, s[52:55], 0 offen sc1
  s_waitcnt vmcnt(0)
  s_nop 0
  s_branch L_p1_done
L_p1_main:
  s_and_b32 s68, s36, 1
  s_lshr_b32 s69, s36, 1
  v_and_b32 v5, 31, v1
  s_lshl_b32 s64, s68, 5
  v_add_u32 v5, s64, v5
  s_mov_b32 s64, 1040
  v_mul_lo_u32 v9, v5, s64
  v_lshrrev_b32 v5, 5, v1
  v_lshlrev_b32 v5, 4, v5
  v_add_u32 v9, v9, v5
  v_and_b32 v5, 15, v1
  v_lshrrev_b32 v6, 2, v5
  v_lshrrev_b32 v7, 5, v1
  v_lshlrev_b32 v7, 3, v7
  v_add_u32 v6, v6, v7
  v_lshlrev_b32 v10, 7, v6
  v_lshrrev_b32 v6, 3, v5
  v_xor_b32 v6, s69, v6
  v_lshlrev_b32 v6, 6, v6
  v_add_u32 v10, v10, v6
  v_and_b32 v6, 16, v1
  v_lshlrev_b32 v6, 1, v6
  v_add_u32 v10, v10, v6
  v_and_b32 v6, 3, v5
  v_lshlrev_b32 v6, 3, v6
  v_add_u32 v10, v10, v6
  v_add_u32 v10, 66560, v10
  v_add_u32 v11, 36864, v10
  s_waitcnt lgkmcnt(0)
  s_barrier
  ds_read_b128 v[64:67], v9 offset:0
  ds_read_b64_tr_b16 v[68:69], v10 offset:0
  ds_read_b64_tr_b16 v[70:71], v10 offset:512
  ds_read_b64_tr_b16 v[72:73], v10 offset:4096
  ds_read_b64_tr_b16 v[74:75], v10 offset:4608
  ds_read_b64_tr_b16 v[76:77], v10 offset:8192
  ds_read_b64_tr_b16 v[78:79], v10 offset:8704
  ds_read_b128 v[80:83], v9 offset:32
  ds_read_b64_tr_b16 v[84:85], v10 offset:2048
  ds_read_b64_tr_b16 v[86:87], v10 offset:2560
  ds_read_b64_tr_b16 v[88:89], v10 offset:6144
  ds_read_b64_tr_b16 v[90:91], v10 offset:6656
  ds_read_b64_tr_b16 v[92:93], v10 offset:10240
  ds_read_b64_tr_b16 v[94:95], v10 offset:10752
  s_waitcnt lgkmcnt(11)
  v_mfma_f32_32x32x16_bf16 v[128:143], v[68:71], v[64:67], 0
  s_barrier
  ds_read_b128 v[96:99], v9 offset:64
  ds_read_b64_tr_b16 v[100:101], v10 offset:12288
  ds_read_b64_tr_b16 v[102:103], v10 offset:12800
  s_waitcnt lgkmcnt(12)
  v_mfma_f32_32x32x16_bf16 v[144:159], v[72:75], v[64:67], 0
  ds_read_b64_tr_b16 v[104:105], v10 offset:16384
  ds_read_b64_tr_b16 v[106:107], v10 offset:16896
  s_waitcnt lgkmcnt(12)
  v_mfma_f32_32x32x16_bf16 v[160:175], v[64:67], v[76:79], 0
  ds_read_b64_tr_b16 v[108:109], v10 offset:20480
  ds_read_b64_tr_b16 v[110:111], v10 offset:20992
  s_waitcnt lgkmcnt(11)
  v_mfma_f32_32x32x16_bf16 v[128:143], v[84:87], v[80:83], v[128:143]
  ds_read_b128 v[64:67], v9 offset:96
  ds_read_b64_tr_b16 v[68:69], v10 offset:14336
  ds_read_b64_tr_b16 v[70:71], v10 offset:14848
  s_waitcnt lgkmcnt(12)
  v_mfma_f32_32x32x16_bf16 v[144:159], v[88:91], v[80:83], v[144:159]
  ds_read_b64_tr_b16 v[72:73], v10 offset:18432
  ds_read_b64_tr_b16 v[74:75], v10 offset:18944
  s_waitcnt lgkmcnt(12)
  v_mfma_f32_32x32x16_bf16 v[160:175], v[80:83], v[92:95], v[160:175]
  ds_read_b64_tr_b16 v[76:77], v10 offset:22528
  ds_read_b64_tr_b16 v[78:79], v10 offset:23040
  s_waitcnt lgkmcnt(11)
  v_mfma_f32_32x32x16_bf16 v[128:143], v[100:103], v[96:99], v[128:143]
  s_barrier
  ds_read_b128 v[80:83], v9 offset:128
  ds_read_b64_tr_b16 v[84:85], v10 offset:24576
  ds_read_b64_tr_b16 v[86:87], v10 offset:25088
  s_waitcnt lgkmcnt(12)
  v_mfma_f32_32x32x16_bf16 v[144:159], v[104:107], v[96:99], v[144:159]
  ds_read_b64_tr_b16 v[88:89], v10 offset:28672
  ds_read_b64_tr_b16 v[90:91], v10 offset:29184
  s_waitcnt lgkmcnt(12)
  v_mfma_f32_32x32x16_bf16 v[160:175], v[96:99], v[108:111], v[160:175]
  ds_read_b64_tr_b16 v[92:93], v10 offset:32768
  ds_read_b64_tr_b16 v[94:95], v10 offset:33280
  s_waitcnt lgkmcnt(11)
  v_mfma_f32_32x32x16_bf16 v[128:143], v[68:71], v[64:67], v[128:143]
  ds_read_b128 v[96:99], v9 offset:160
  ds_read_b64_tr_b16 v[100:101], v10 offset:26624
  ds_read_b64_tr_b16 v[102:103], v10 offset:27136
  s_waitcnt lgkmcnt(12)
  v_mfma_f32_32x32x16_bf16 v[144:159], v[72:75], v[64:67], v[144:159]
  ds_read_b64_tr_b16 v[104:105], v10 offset:30720
  ds_read_b64_tr_b16 v[106:107], v10 offset:31232
  s_waitcnt lgkmcnt(12)
  v_mfma_f32_32x32x16_bf16 v[160:175], v[64:67], v[76:79], v[160:175]
  ds_read_b64_tr_b16 v[108:109], v10 offset:34816
  ds_read_b64_tr_b16 v[110:111], v10 offset:35328
  s_waitcnt lgkmcnt(11)
  v_mfma_f32_32x32x16_bf16 v[128:143], v[84:87], v[80:83], v[128:143]
  s_barrier
  ds_read_b128 v[64:67], v9 offset:192
  ds_read_b64_tr_b16 v[68:69], v11 offset:0
  ds_read_b64_tr_b16 v[70:71], v11 offset:512
  s_waitcnt lgkmcnt(12)
  v_mfma_f32_32x32x16_bf16 v[144:159], v[88:91], v[80:83], v[144:159]
  ds_read_b64_tr_b16 v[72:73], v11 offset:4096
  ds_read_b64_tr_b16 v[74:75], v11 offset:4608
  s_waitcnt lgkmcnt(12)
  v_mfma_f32_32x32x16_bf16 v[160:175], v[80:83], v[92:95], v[160:175]
  ds_read_b64_tr_b16 v[76:77], v11 offset:8192
  ds_read_b64_tr_b16 v[78:79], v11 offset:8704
  s_waitcnt lgkmcnt(11)
  v_mfma_f32_32x32x16_bf16 v[128:143], v[100:103], v[96:99], v[128:143]
  ds_read_b128 v[80:83], v9 offset:224
  ds_read_b64_tr_b16 v[84:85], v11 offset:2048
  ds_read_b64_tr_b16 v[86:87], v11 offset:2560
  s_waitcnt lgkmcnt(12)
  v_mfma_f32_32x32x16_bf16 v[144:159], v[104:107], v[96:99], v[144:159]
  ds_read_b64_tr_b16 v[88:89], v11 offset:6144
  ds_read_b64_tr_b16 v[90:91], v11 offset:6656
  s_waitcnt lgkmcnt(12)
  v_mfma_f32_32x32x16_bf16 v[160:175], v[96:99], v[108:111], v[160:175]
  ds_read_b64_tr_b16 v[92:93], v11 offset:10240
  ds_read_b64_tr_b16 v[94:95], v11 offset:10752
  s_waitcnt lgkmcnt(11)
  v_mfma_f32_32x32x16_bf16 v[128:143], v[68:71], v[64:67], v[128:143]
  s_barrier
  ds_read_b128 v[96:99], v9 offset:256
  ds_read_b64_tr_b16 v[100:101], v11 offset:12288
  ds_read_b64_tr_b16 v[102:103], v11 offset:12800
  s_waitcnt lgkmcnt(12)
  v_mfma_f32_32x32x16_bf16 v[144:159], v[72:75], v[64:67], v[144:159]
  ds_read_b64_tr_b16 v[104:105], v11 offset:16384
  ds_read_b64_tr_b16 v[106:107], v11 offset:16896
  s_waitcnt lgkmcnt(12)
  v_mfma_f32_32x32x16_bf16 v[160:175], v[64:67], v[76:79], v[160:175]
  ds_read_b64_tr_b16 v[108:109], v11 offset:20480
  ds_read_b64_tr_b16 v[110:111], v11 offset:20992
  s_waitcnt lgkmcnt(11)
  v_mfma_f32_32x32x16_bf16 v[128:143], v[84:87], v[80:83], v[128:143]
  ds_read_b128 v[64:67], v9 offset:288
  ds_read_b64_tr_b16 v[68:69], v11 offset:14336
  ds_read_b64_tr_b16 v[70:71], v11 offset:14848
  s_waitcnt lgkmcnt(12)
  v_mfma_f32_32x32x16_bf16 v[144:159], v[88:91], v[80:83], v[144:159]
  ds_read_b64_tr_b16 v[72:73], v11 offset:18432
  ds_read_b64_tr_b16 v[74:75], v11 offset:18944
  s_waitcnt lgkmcnt(12)
  v_mfma_f32_32x32x16_bf16 v[160:175], v[80:83], v[92:95], v[160:175]
  ds_read_b64_tr_b16 v[76:77], v11 offset:22528
  ds_read_b64_tr_b16 v[78:79], v11 offset:23040
  s_waitcnt lgkmcnt(11)
  v_mfma_f32_32x32x16_bf16 v[128:143], v[100:103], v[96:99], v[128:143]
  s_barrier
  ds_read_b128 v[80:83], v9 offset:320
  ds_read_b64_tr_b16 v[84:85], v11 offset:24576
  ds_read_b64_tr_b16 v[86:87], v11 offset:25088
  s_waitcnt lgkmcnt(12)
  v_mfma_f32_32x32x16_bf16 v[144:159], v[104:107], v[96:99], v[144:159]
  ds_read_b64_tr_b16 v[88:89], v11 offset:28672
  ds_read_b64_tr_b16 v[90:91], v11 offset:29184
  s_waitcnt lgkmcnt(12)
  v_mfma_f32_32x32x16_bf16 v[160:175], v[96:99], v[108:111], v[160:175]
  ds_read_b64_tr_b16 v[92:93], v11 offset:32768
  ds_read_b64_tr_b16 v[94:95], v11 offset:33280
  s_waitcnt lgkmcnt(11)
  v_mfma_f32_32x32x16_bf16 v[128:143], v[68:71], v[64:67], v[128:143]
  ds_read_b128 v[96:99], v9 offset:352
  ds_read_b64_tr_b16 v[100:101], v11 offset:26624
  ds_read_b64_tr_b16 v[102:103], v11 offset:27136
  s_waitcnt lgkmcnt(12)
  v_mfma_f32_32x32x16_bf16 v[144:159], v[72:75], v[64:67], v[144:159]
  ds_read_b64_tr_b16 v[104:105], v11 offset:30720
  ds_read_b64_tr_b16 v[106:107], v11 offset:31232
  s_waitcnt lgkmcnt(12)
  v_mfma_f32_32x32x16_bf16 v[160:175], v[64:67], v[76:79], v[160:175]
  ds_read_b64_tr_b16 v[108:109], v11 offset:34816
  ds_read_b64_tr_b16 v[110:111], v11 offset:35328
  s_waitcnt lgkmcnt(11)
  v_mfma_f32_32x32x16_bf16 v[128:143], v[84:87], v[80:83], v[128:143]
  s_barrier
  ds_read_b128 v[64:67], v9 offset:384
  ds_read_b64_tr_b16 v[68:69], v10 offset:0
  ds_read_b64_tr_b16 v[70:71], v10 offset:512
  s_waitcnt lgkmcnt(12)
  v_mfma_f32_32x32x16_bf16 v[144:159], v[88:91], v[80:83], v[144:159]
  ds_read_b64_tr_b16 v[72:73], v10 offset:4096
  ds_read_b64_tr_b16 v[74:75], v10 offset:4608
  s_waitcnt lgkmcnt(12)
  v_mfma_f32_32x32x16_bf16 v[160:175], v[80:83], v[92:95], v[160:175]
  ds_read_b64_tr_b16 v[76:77], v10 offset:8192
  ds_read_b64_tr_b16 v[78:79], v10 offset:8704
  s_waitcnt lgkmcnt(11)
  v_mfma_f32_32x32x16_bf16 v[128:143], v[100:103], v[96:99], v[128:143]
  ds_read_b128 v[80:83], v9 offset:416
  ds_read_b64_tr_b16 v[84:85], v10 offset:2048
  ds_read_b64_tr_b16 v[86:87], v10 offset:2560
  s_waitcnt lgkmcnt(12)
  v_mfma_f32_32x32x16_bf16 v[144:159], v[104:107], v[96:99], v[144:159]
  ds_read_b64_tr_b16 v[88:89], v10 offset:6144
  ds_read_b64_tr_b16 v[90:91], v10 offset:6656
  s_waitcnt lgkmcnt(12)
  v_mfma_f32_32x32x16_bf16 v[160:175], v[96:99], v[108:111], v[160:175]
  ds_read_b64_tr_b16 v[92:93], v10 offset:10240
  ds_read_b64_tr_b16 v[94:95], v10 offset:10752
  s_waitcnt lgkmcnt(11)
  v_mfma_f32_32x32x16_bf16 v[128:143], v[68:71], v[64:67], v[128:143]
  s_barrier
  ds_read_b128 v[96:99], v9 offset:448
  ds_read_b64_tr_b16 v[100:101], v10 offset:12288
  ds_read_b64_tr_b16 v[102:103], v10 offset:12800
  s_waitcnt lgkmcnt(12)
  v_mfma_f32_32x32x16_bf16 v[144:159], v[72:75], v[64:67], v[144:159]
  ds_read_b64_tr_b16 v[104:105], v10 offset:16384
  ds_read_b64_tr_b16 v[106:107], v10 offset:16896
  s_waitcnt lgkmcnt(12)
  v_mfma_f32_32x32x16_bf16 v[160:175], v[64:67], v[76:79], v[160:175]
  ds_read_b64_tr_b16 v[108:109], v10 offset:20480
  ds_read_b64_tr_b16 v[110:111], v10 offset:20992
  s_waitcnt lgkmcnt(11)
  v_mfma_f32_32x32x16_bf16 v[128:143], v[84:87], v[80:83], v[128:143]
  ds_read_b128 v[64:67], v9 offset:480
  ds_read_b64_tr_b16 v[68:69], v10 offset:14336
  ds_read_b64_tr_b16 v[70:71], v10 offset:14848
  s_waitcnt lgkmcnt(12)
  v_mfma_f32_32x32x16_bf16 v[144:159], v[88:91], v[80:83], v[144:159]
  ds_read_b64_tr_b16 v[72:73], v10 offset:18432
  ds_read_b64_tr_b16 v[74:75], v10 offset:18944
  s_waitcnt lgkmcnt(12)
  v_mfma_f32_32x32x16_bf16 v[160:175], v[80:83], v[92:95], v[160:175]
  ds_read_b64_tr_b16 v[76:77], v10 offset:22528
  ds_read_b64_tr_b16 v[78:79], v10 offset:23040
  s_waitcnt lgkmcnt(11)
  v_mfma_f32_32x32x16_bf16 v[128:143], v[100:103], v[96:99], v[128:143]
  s_barrier
  ds_read_b128 v[80:83], v9 offset:512
  ds_read_b64_tr_b16 v[84:85], v10 offset:24576
  ds_read_b64_tr_b16 v[86:87], v10 offset:25088
  s_waitcnt lgkmcnt(12)
  v_mfma_f32_32x32x16_bf16 v[144:159], v[104:107], v[96:99], v[144:159]
  ds_read_b64_tr_b16 v[88:89], v10 offset:28672
  ds_read_b64_tr_b16 v[90:91], v10 offset:29184
  s_waitcnt lgkmcnt(12)
  v_mfma_f32_32x32x16_bf16 v[160:175], v[96:99], v[108:111], v[160:175]
  ds_read_b64_tr_b16 v[92:93], v10 offset:32768
  ds_read_b64_tr_b16 v[94:95], v10 offset:33280
  s_waitcnt lgkmcnt(11)
  v_mfma_f32_32x32x16_bf16 v[128:143], v[68:71], v[64:67], v[128:143]
  ds_read_b128 v[96:99], v9 offset:544
  ds_read_b64_tr_b16 v[100:101], v10 offset:26624
  ds_read_b64_tr_b16 v[102:103], v10 offset:27136
  s_waitcnt lgkmcnt(12)
  v_mfma_f32_32x32x16_bf16 v[144:159], v[72:75], v[64:67], v[144:159]
  ds_read_b64_tr_b16 v[104:105], v10 offset:30720
  ds_read_b64_tr_b16 v[106:107], v10 offset:31232
  s_waitcnt lgkmcnt(12)
  v_mfma_f32_32x32x16_bf16 v[160:175], v[64:67], v[76:79], v[160:175]
  ds_read_b64_tr_b16 v[108:109], v10 offset:34816
  ds_read_b64_tr_b16 v[110:111], v10 offset:35328
  s_waitcnt lgkmcnt(11)
  v_mfma_f32_32x32x16_bf16 v[128:143], v[84:87], v[80:83], v[128:143]
  s_barrier
  ds_read_b128 v[64:67], v9 offset:576
  ds_read_b64_tr_b16 v[68:69], v11 offset:0
  ds_read_b64_tr_b16 v[70:71], v11 offset:512
  s_waitcnt lgkmcnt(12)
  v_mfma_f32_32x32x16_bf16 v[144:159], v[88:91], v[80:83], v[144:159]
  ds_read_b64_tr_b16 v[72:73], v11 offset:4096
  ds_read_b64_tr_b16 v[74:75], v11 offset:4608
  s_waitcnt lgkmcnt(12)
  v_mfma_f32_32x32x16_bf16 v[160:175], v[80:83], v[92:95], v[160:175]
  ds_read_b64_tr_b16 v[76:77], v11 offset:8192
  ds_read_b64_tr_b16 v[78:79], v11 offset:8704
  s_waitcnt lgkmcnt(11)
  v_mfma_f32_32x32x16_bf16 v[128:143], v[100:103], v[96:99], v[128:143]
  ds_read_b128 v[80:83], v9 offset:608
  ds_read_b64_tr_b16 v[84:85], v11 offset:2048
  ds_read_b64_tr_b16 v[86:87], v11 offset:2560
  s_waitcnt lgkmcnt(12)
  v_mfma_f32_32x32x16_bf16 v[144:159], v[104:107], v[96:99], v[144:159]
  ds_read_b64_tr_b16 v[88:89], v11 offset:6144
  ds_read_b64_tr_b16 v[90:91], v11 offset:6656
  s_waitcnt lgkmcnt(12)
  v_mfma_f32_32x32x16_bf16 v[160:175], v[96:99], v[108:111], v[160:175]
  ds_read_b64_tr_b16 v[92:93], v11 offset:10240
  ds_read_b64_tr_b16 v[94:95], v11 offset:10752
  s_waitcnt lgkmcnt(11)
  v_mfma_f32_32x32x16_bf16 v[128:143], v[68:71], v[64:67], v[128:143]
  s_barrier
  ds_read_b128 v[96:99], v9 offset:640
  ds_read_b64_tr_b16 v[100:101], v11 offset:12288
  ds_read_b64_tr_b16 v[102:103], v11 offset:12800
  s_waitcnt lgkmcnt(12)
  v_mfma_f32_32x32x16_bf16 v[144:159], v[72:75], v[64:67], v[144:159]
  ds_read_b64_tr_b16 v[104:105], v11 offset:16384
  ds_read_b64_tr_b16 v[106:107], v11 offset:16896
  s_waitcnt lgkmcnt(12)
  v_mfma_f32_32x32x16_bf16 v[160:175], v[64:67], v[76:79], v[160:175]
  ds_read_b64_tr_b16 v[108:109], v11 offset:20480
  ds_read_b64_tr_b16 v[110:111], v11 offset:20992
  s_waitcnt lgkmcnt(11)
  v_mfma_f32_32x32x16_bf16 v[128:143], v[84:87], v[80:83], v[128:143]
  ds_read_b128 v[64:67], v9 offset:672
  ds_read_b64_tr_b16 v[68:69], v11 offset:14336
  ds_read_b64_tr_b16 v[70:71], v11 offset:14848
  s_waitcnt lgkmcnt(12)
  v_mfma_f32_32x32x16_bf16 v[144:159], v[88:91], v[80:83], v[144:159]
  ds_read_b64_tr_b16 v[72:73], v11 offset:18432
  ds_read_b64_tr_b16 v[74:75], v11 offset:18944
  s_waitcnt lgkmcnt(12)
  v_mfma_f32_32x32x16_bf16 v[160:175], v[80:83], v[92:95], v[160:175]
  ds_read_b64_tr_b16 v[76:77], v11 offset:22528
  ds_read_b64_tr_b16 v[78:79], v11 offset:23040
  s_waitcnt lgkmcnt(11)
  v_mfma_f32_32x32x16_bf16 v[128:143], v[100:103], v[96:99], v[128:143]
  s_barrier
  ds_read_b128 v[80:83], v9 offset:704
  ds_read_b64_tr_b16 v[84:85], v11 offset:24576
  ds_read_b64_tr_b16 v[86:87], v11 offset:25088
  s_waitcnt lgkmcnt(12)
  v_mfma_f32_32x32x16_bf16 v[144:159], v[104:107], v[96:99], v[144:159]
  ds_read_b64_tr_b16 v[88:89], v11 offset:28672
  ds_read_b64_tr_b16 v[90:91], v11 offset:29184
  s_waitcnt lgkmcnt(12)
  v_mfma_f32_32x32x16_bf16 v[160:175], v[96:99], v[108:111], v[160:175]
  ds_read_b64_tr_b16 v[92:93], v11 offset:32768
  ds_read_b64_tr_b16 v[94:95], v11 offset:33280
  s_waitcnt lgkmcnt(11)
  v_mfma_f32_32x32x16_bf16 v[128:143], v[68:71], v[64:67], v[128:143]
  ds_read_b128 v[96:99], v9 offset:736
  ds_read_b64_tr_b16 v[100:101], v11 offset:26624
  ds_read_b64_tr_b16 v[102:103], v11 offset:27136
  s_waitcnt lgkmcnt(12)
  v_mfma_f32_32x32x16_bf16 v[144:159], v[72:75], v[64:67], v[144:159]
  ds_read_b64_tr_b16 v[104:105], v11 offset:30720
  ds_read_b64_tr_b16 v[106:107], v11 offset:31232
  s_waitcnt lgkmcnt(12)
  v_mfma_f32_32x32x16_bf16 v[160:175], v[64:67], v[76:79], v[160:175]
  ds_read_b64_tr_b16 v[108:109], v11 offset:34816
  ds_read_b64_tr_b16 v[110:111], v11 offset:35328
  s_waitcnt lgkmcnt(11)
  v_mfma_f32_32x32x16_bf16 v[128:143], v[84:87], v[80:83], v[128:143]
  s_barrier
  ds_read_b128 v[64:67], v9 offset:768
  ds_read_b64_tr_b16 v[68:69], v10 offset:0
  ds_read_b64_tr_b16 v[70:71], v10 offset:512
  s_waitcnt lgkmcnt(12)
  v_mfma_f32_32x32x16_bf16 v[144:159], v[88:91], v[80:83], v[144:159]
  ds_read_b64_tr_b16 v[72:73], v10 offset:4096
  ds_read_b64_tr_b16 v[74:75], v10 offset:4608
  s_waitcnt lgkmcnt(12)
  v_mfma_f32_32x32x16_bf16 v[160:175], v[80:83], v[92:95], v[160:175]
  ds_read_b64_tr_b16 v[76:77], v10 offset:8192
  ds_read_b64_tr_b16 v[78:79], v10 offset:8704
  s_waitcnt lgkmcnt(11)
  v_mfma_f32_32x32x16_bf16 v[128:143], v[100:103], v[96:99], v[128:143]
  ds_read_b128 v[80:83], v9 offset:800
  ds_read_b64_tr_b16 v[84:85], v10 offset:2048
  ds_read_b64_tr_b16 v[86:87], v10 offset:2560
  s_waitcnt lgkmcnt(12)
  v_mfma_f32_32x32x16_bf16 v[144:159], v[104:107], v[96:99], v[144:159]
  ds_read_b64_tr_b16 v[88:89], v10 offset:6144
  ds_read_b64_tr_b16 v[90:91], v10 offset:6656
  s_waitcnt lgkmcnt(12)
  v_mfma_f32_32x32x16_bf16 v[160:175], v[96:99], v[108:111], v[160:175]
  ds_read_b64_tr_b16 v[92:93], v10 offset:10240
  ds_read_b64_tr_b16 v[94:95], v10 offset:10752
  s_waitcnt lgkmcnt(11)
  v_mfma_f32_32x32x16_bf16 v[128:143], v[68:71], v[64:67], v[128:143]
  s_barrier
  ds_read_b128 v[96:99], v9 offset:832
  ds_read_b64_tr_b16 v[100:101], v10 offset:12288
  ds_read_b64_tr_b16 v[102:103], v10 offset:12800
  s_waitcnt lgkmcnt(12)
  v_mfma_f32_32x32x16_bf16 v[144:159], v[72:75], v[64:67], v[144:159]
  ds_read_b64_tr_b16 v[104:105], v10 offset:16384
  ds_read_b64_tr_b16 v[106:107], v10 offset:16896
  s_waitcnt lgkmcnt(12)
  v_mfma_f32_32x32x16_bf16 v[160:175], v[64:67], v[76:79], v[160:175]
  ds_read_b64_tr_b16 v[108:109], v10 offset:20480
  ds_read_b64_tr_b16 v[110:111], v10 offset:20992
  s_waitcnt lgkmcnt(11)
  v_mfma_f32_32x32x16_bf16 v[128:143], v[84:87], v[80:83], v[128:143]
  ds_read_b128 v[64:67], v9 offset:864
  ds_read_b64_tr_b16 v[68:69], v10 offset:14336
  ds_read_b64_tr_b16 v[70:71], v10 offset:14848
  s_waitcnt lgkmcnt(12)
  v_mfma_f32_32x32x16_bf16 v[144:159], v[88:91], v[80:83], v[144:159]
  ds_read_b64_tr_b16 v[72:73], v10 offset:18432
  ds_read_b64_tr_b16 v[74:75], v10 offset:18944
  s_waitcnt lgkmcnt(12)
  v_mfma_f32_32x32x16_bf16 v[160:175], v[80:83], v[92:95], v[160:175]
  ds_read_b64_tr_b16 v[76:77], v10 offset:22528
  ds_read_b64_tr_b16 v[78:79], v10 offset:23040
  s_waitcnt lgkmcnt(11)
  v_mfma_f32_32x32x16_bf16 v[128:143], v[100:103], v[96:99], v[128:143]
  s_barrier
  ds_read_b128 v[80:83], v9 offset:896
  ds_read_b64_tr_b16 v[84:85], v10 offset:24576
  ds_read_b64_tr_b16 v[86:87], v10 offset:25088
  s_waitcnt lgkmcnt(12)
  v_mfma_f32_32x32x16_bf16 v[144:159], v[104:107], v[96:99], v[144:159]
  ds_read_b64_tr_b16 v[88:89], v10 offset:28672
  ds_read_b64_tr_b16 v[90:91], v10 offset:29184
  s_waitcnt lgkmcnt(12)
  v_mfma_f32_32x32x16_bf16 v[160:175], v[96:99], v[108:111], v[160:175]
  ds_read_b64_tr_b16 v[92:93], v10 offset:32768
  ds_read_b64_tr_b16 v[94:95], v10 offset:33280
  s_waitcnt lgkmcnt(11)
  v_mfma_f32_32x32x16_bf16 v[128:143], v[68:71], v[64:67], v[128:143]
  ds_read_b128 v[96:99], v9 offset:928
  ds_read_b64_tr_b16 v[100:101], v10 offset:26624
  ds_read_b64_tr_b16 v[102:103], v10 offset:27136
  s_waitcnt lgkmcnt(12)
  v_mfma_f32_32x32x16_bf16 v[144:159], v[72:75], v[64:67], v[144:159]
  ds_read_b64_tr_b16 v[104:105], v10 offset:30720
  ds_read_b64_tr_b16 v[106:107], v10 offset:31232
  s_waitcnt lgkmcnt(12)
  v_mfma_f32_32x32x16_bf16 v[160:175], v[64:67], v[76:79], v[160:175]
  ds_read_b64_tr_b16 v[108:109], v10 offset:34816
  ds_read_b64_tr_b16 v[110:111], v10 offset:35328
  s_waitcnt lgkmcnt(11)
  v_mfma_f32_32x32x16_bf16 v[128:143], v[84:87], v[80:83], v[128:143]
  s_barrier
  ds_read_b128 v[64:67], v9 offset:960
  ds_read_b64_tr_b16 v[68:69], v11 offset:0
  ds_read_b64_tr_b16 v[70:71], v11 offset:512
  s_waitcnt lgkmcnt(12)
  v_mfma_f32_32x32x16_bf16 v[144:159], v[88:91], v[80:83], v[144:159]
  ds_read_b64_tr_b16 v[72:73], v11 offset:4096
  ds_read_b64_tr_b16 v[74:75], v11 offset:4608
  s_waitcnt lgkmcnt(12)
  v_mfma_f32_32x32x16_bf16 v[160:175], v[80:83], v[92:95], v[160:175]
  ds_read_b64_tr_b16 v[76:77], v11 offset:8192
  ds_read_b64_tr_b16 v[78:79], v11 offset:8704
  s_waitcnt lgkmcnt(11)
  v_mfma_f32_32x32x16_bf16 v[128:143], v[100:103], v[96:99], v[128:143]
  ds_read_b128 v[80:83], v9 offset:992
  ds_read_b64_tr_b16 v[84:85], v11 offset:2048
  ds_read_b64_tr_b16 v[86:87], v11 offset:2560
  s_waitcnt lgkmcnt(12)
  v_mfma_f32_32x32x16_bf16 v[144:159], v[104:107], v[96:99], v[144:159]
  ds_read_b64_tr_b16 v[88:89], v11 offset:6144
  ds_read_b64_tr_b16 v[90:91], v11 offset:6656
  s_waitcnt lgkmcnt(12)
  v_mfma_f32_32x32x16_bf16 v[160:175], v[96:99], v[108:111], v[160:175]
  ds_read_b64_tr_b16 v[92:93], v11 offset:10240
  ds_read_b64_tr_b16 v[94:95], v11 offset:10752
  s_waitcnt lgkmcnt(11)
  v_mfma_f32_32x32x16_bf16 v[128:143], v[68:71], v[64:67], v[128:143]
  s_waitcnt lgkmcnt(9)
  v_mfma_f32_32x32x16_bf16 v[144:159], v[72:75], v[64:67], v[144:159]
  s_waitcnt lgkmcnt(7)
  v_mfma_f32_32x32x16_bf16 v[160:175], v[64:67], v[76:79], v[160:175]
  s_waitcnt lgkmcnt(4)
  v_mfma_f32_32x32x16_bf16 v[128:143], v[84:87], v[80:83], v[128:143]
  s_waitcnt lgkmcnt(2)
  v_mfma_f32_32x32x16_bf16 v[144:159], v[88:91], v[80:83], v[144:159]
  s_waitcnt lgkmcnt(0)
  v_mfma_f32_32x32x16_bf16 v[160:175], v[80:83], v[92:95], v[160:175]
  s_mov_b32 s52, s32
  s_and_b32 s53, s33, 0xffff
  s_mov_b32 s54, 0x100
  s_mov_b32 s55, 0x20000
  v_mov_b32 v29, 0
  buffer_load_dword v28, v29, s[52:55], 0 offen sc1
  s_lshl_b32 s70, s63, 2
  s_lshl_b32 s65, s69, 1
  s_add_u32 s70, s70, s65
  s_lshl_b32 s71, s62, 1
  s_add_u32 s71, s71, s68
  s_lshl_b32 s64, s70, 16
  s_lshl_b32 s65, s71, 10
  s_add_u32 s64, s64, s65
  v_and_b32 v5, 15, v1
  v_lshlrev_b32 v11, 4, v5
  v_lshrrev_b32 v5, 5, v1
  v_lshlrev_b32 v5, 8, v5
  v_add_u32 v11, v11, v5
  v_and_b32 v5, 16, v1
  v_lshlrev_b32 v5, 12, v5
  v_add_u32 v11, v11, v5
  s_mov_b32 s72, 0x3eb8aa3b
  v_cvt_pk_bf16_f32 v32, v144, v145
  v_cvt_pk_bf16_f32 v33, v146, v147
  v_cvt_pk_bf16_f32 v34, v148, v149
  v_cvt_pk_bf16_f32 v35, v150, v151
  s_add_u32 s65, s64, 2097152
  buffer_store_dwordx4 v[32:35], v2, s[48:51], s65 offen sc1
  v_cvt_pk_bf16_f32 v36, v152, v153
  v_cvt_pk_bf16_f32 v37, v154, v155
  v_cvt_pk_bf16_f32 v38, v156, v157
  v_cvt_pk_bf16_f32 v39, v158, v159
  s_add_u32 s65, s64, 2162688
  buffer_store_dwordx4 v[36:39], v2, s[48:51], s65 offen sc1
  v_mul_f32 v128, s72, v128
  v_mul_f32 v129, s72, v129
  v_cvt_pk_bf16_f32 v40, v128, v129
  v_mul_f32 v130, s72, v130
  v_mul_f32 v131, s72, v131
  v_cvt_pk_bf16_f32 v41, v130, v131
  v_mul_f32 v132, s72, v132
  v_mul_f32 v133, s72, v133
  v_cvt_pk_bf16_f32 v42, v132, v133
  v_mul_f32 v134, s72, v134
  v_mul_f32 v135, s72, v135
  v_cvt_pk_bf16_f32 v43, v134, v135
  s_add_u32 s65, s64, 0
  buffer_store_dwordx4 v[40:43], v2, s[48:51], s65 offen sc1
  v_mul_f32 v136, s72, v136
  v_mul_f32 v137, s72, v137
  v_cvt_pk_bf16_f32 v44, v136, v137
  v_mul_f32 v138, s72, v138
  v_mul_f32 v139, s72, v139
  v_cvt_pk_bf16_f32 v45, v138, v139
  v_mul_f32 v140, s72, v140
  v_mul_f32 v141, s72, v141
  v_cvt_pk_bf16_f32 v46, v140, v141
  v_mul_f32 v142, s72, v142
  v_mul_f32 v143, s72, v143
  v_cvt_pk_bf16_f32 v47, v142, v143
  s_add_u32 s65, s64, 65536
  buffer_store_dwordx4 v[44:47], v2, s[48:51], s65 offen sc1
  v_cvt_pk_bf16_f32 v48, v160, v161
  v_cvt_pk_bf16_f32 v49, v162, v163
  v_cvt_pk_bf16_f32 v50, v164, v165
  v_cvt_pk_bf16_f32 v51, v166, v167
  s_add_u32 s65, s64, 4194304
  buffer_store_dwordx4 v[48:51], v11, s[48:51], s65 offen sc1
  v_cvt_pk_bf16_f32 v52, v168, v169
  v_cvt_pk_bf16_f32 v53, v170, v171
  v_cvt_pk_bf16_f32 v54, v172, v173
  v_cvt_pk_bf16_f32 v55, v174, v175
  s_add_u32 s65, s64, 4194816
  buffer_store_dwordx4 v[52:55], v11, s[48:51], s65 offen sc1
  s_waitcnt vmcnt(0)
  s_nop 0
L_p1_done:
  s_mov_b32 s79, 0
L_eget:
  v_readfirstlane_b32 s56, v28
  s_add_u32 s79, s79, 1
  s_cmp_lg_u32 s56, 0
  s_cbranch_scc1 L_eget_ok
  s_cmp_gt_u32 s79, 0x40000
  s_cbranch_scc1 L_eget_ok
  buffer_load_dword v28, v29, s[52:55], 0 offen sc1
  s_waitcnt vmcnt(0)
  s_branch L_eget
L_eget_ok:
  s_barrier
  s_mov_b32 s70, s63
  s_mov_b32 s71, s62
  s_cmp_lg_u32 s36, 0
  s_cbranch_scc1 L_sig0
  s_lshl_b32 s78, s70, 11
  s_add_u32 s78, s78, 19922944
  s_lshl_b32 s79, s71, 6
  s_add_u32 s78, s78, s79
  v_mov_b32 v10, s56
  v_mov_b32 v11, 0
  s_mov_b64 exec, 1
  buffer_store_dword v10, v11, s[48:51], s78 offen sc1
  s_mov_b64 exec, -1
L_sig0:
  s_and_b32 s64, s39, 3
  s_and_b32 s62, s2, 7
  s_lshl_b32 s62, s62, 2
  s_add_u32 s62, s62, s64
  s_lshr_b32 s63, s39, 2
  s_cmp_eq_u32 s63, 0
  s_cselect_b32 s67, 8, 0
  v_and_b32 v4, 31, v1
  v_lshrrev_b32 v5, 5, v1
  v_lshlrev_b32 v5, 2, v5
  v_sub_u32 v4, v4, v5
  v_cmp_gt_i32 vcc, 0, v4
  s_nop 1
  v_cndmask_b32 v16, 0, -1, vcc
  v_cmp_gt_i32 vcc, 1, v4
  s_nop 1
  v_cndmask_b32 v17, 0, -1, vcc
  v_cmp_gt_i32 vcc, 2, v4
  s_nop 1
  v_cndmask_b32 v18, 0, -1, vcc
  v_cmp_gt_i32 vcc, 3, v4
  s_nop 1
  v_cndmask_b32 v19, 0, -1, vcc
  v_cmp_gt_i32 vcc, 8, v4
  s_nop 1
  v_cndmask_b32 v20, 0, -1, vcc
  v_cmp_gt_i32 vcc, 9, v4
  s_nop 1
  v_cndmask_b32 v21, 0, -1, vcc
  v_cmp_gt_i32 vcc, 10, v4
  s_nop 1
  v_cndmask_b32 v22, 0, -1, vcc
  v_cmp_gt_i32 vcc, 11, v4
  s_nop 1
  v_cndmask_b32 v23, 0, -1, vcc
  v_cmp_gt_i32 vcc, 16, v4
  s_nop 1
  v_cndmask_b32 v24, 0, -1, vcc
  v_cmp_gt_i32 vcc, 17, v4
  s_nop 1
  v_cndmask_b32 v25, 0, -1, vcc
  v_cmp_gt_i32 vcc, 18, v4
  s_nop 1
  v_cndmask_b32 v26, 0, -1, vcc
  v_cmp_gt_i32 vcc, 19, v4
  s_nop 1
  v_cndmask_b32 v27, 0, -1, vcc
  v_cmp_gt_i32 vcc, 24, v4
  s_nop 1
  v_cndmask_b32 v28, 0, -1, vcc
  v_cmp_gt_i32 vcc, 25, v4
  s_nop 1
  v_cndmask_b32 v29, 0, -1, vcc
  v_cmp_gt_i32 vcc, 26, v4
  s_nop 1
  v_cndmask_b32 v30, 0, -1, vcc
  v_cmp_gt_i32 vcc, 27, v4
  s_nop 1
  v_cndmask_b32 v31, 0, -1, vcc
  v_and_b32 v32, 0xffff, v16
  v_and_b32 v5, 0xffff0000, v17
  v_or_b32 v32, v32, v5
  v_and_b32 v33, 0xffff, v18
  v_and_b32 v5, 0xffff0000, v19
  v_or_b32 v33, v33, v5
  v_and_b32 v34, 0xffff, v20
  v_and_b32 v5, 0xffff0000, v21
  v_or_b32 v34, v34, v5
  v_and_b32 v35, 0xffff, v22
  v_and_b32 v5, 0xffff0000, v23
  v_or_b32 v35, v35, v5
  v_and_b32 v36, 0xffff, v24
  v_and_b32 v5, 0xffff0000, v25
  v_or_b32 v36, v36, v5
  v_and_b32 v37, 0xffff, v26
  v_and_b32 v5, 0xffff0000, v27
  v_or_b32 v37, v37, v5
  v_and_b32 v38, 0xffff, v28
  v_and_b32 v5, 0xffff0000, v29
  v_or_b32 v38, v38, v5
  v_and_b32 v39, 0xffff, v30
  v_and_b32 v5, 0xffff0000, v31
  v_or_b32 v39, v39, v5
  v_and_b32 v6, 15, v1
  v_lshlrev_b32 v6, 4, v6
  v_lshrrev_b32 v5, 5, v1
  v_lshlrev_b32 v5, 8, v5
  v_add_u32 v6, v6, v5
  v_add_u32 v6, 16384, v6
  s_lshl_b32 s64, s36, 10
  v_add_u32 v8, s64, v2
  v_add_u32 v9, s64, v6
  v_mov_b32 v76, 0x3f803f80
  v_mov_b32 v77, 0x3f803f80
  v_mov_b32 v78, 0x3f803f80
  v_mov_b32 v79, 0x3f803f80
  v_mov_b32 v80, 0x3f803f80
  v_mov_b32 v81, 0x3f803f80
  v_mov_b32 v82, 0x3f803f80
  v_mov_b32 v83, 0x3f803f80
  v_mov_b32 v84, 0x3f803f80
  v_mov_b32 v85, 0x3f803f80
  v_mov_b32 v86, 0x3f803f80
  v_mov_b32 v87, 0x3f803f80
  v_mov_b32 v88, 0x3f803f80
  v_mov_b32 v89, 0x3f803f80
  v_mov_b32 v90, 0x3f803f80
  v_mov_b32 v91, 0x3f803f80
  v_mov_b32 v92, 0x3f803f80
  v_mov_b32 v93, 0x3f803f80
  v_mov_b32 v94, 0x3f803f80
  v_mov_b32 v95, 0x3f803f80
  v_mov_b32 v96, 0x3f803f80
  v_mov_b32 v97, 0x3f803f80
  v_mov_b32 v98, 0x3f803f80
  v_mov_b32 v99, 0x3f803f80
  s_mov_b32 s76, 0xffff
  s_mov_b32 s77, 0xffff
  s_cmp_lg_u32 s36, 0
  s_cbranch_scc1 L_p2_nopoll
  s_lshr_b32 s69, s62, 2
  s_lshl_b32 s70, s63, 2
  s_sub_u32 s71, s70, 4
  s_cmp_eq_u32 s63, 0
  s_cselect_b32 s70, 0, s71
  s_cselect_b32 s72, 0xf, 0xff
  s_lshl_b32 s78, s69, 11
  s_add_u32 s78, s78, 19922944
  s_lshl_b32 s79, s70, 6
  s_add_u32 s78, s78, s79
  v_lshlrev_b32 v10, 6, v1
  s_mov_b32 exec_lo, s72
  s_mov_b32 exec_hi, 0
  s_mov_b32 s79, 0
  s_waitcnt vmcnt(0)
  buffer_load_dword v11, v10, s[48:51], s78 offen sc1
  s_sleep 3
  buffer_load_dword v12, v10, s[48:51], s78 offen sc1
L_wfp2_poll:
  s_waitcnt vmcnt(1)
  v_cmp_ne_u32 vcc, s56, v11
  s_cbranch_vccz L_wfp2_out
  buffer_load_dword v11, v10, s[48:51], s78 offen sc1
  s_waitcnt vmcnt(1)
  v_cmp_ne_u32 vcc, s56, v12
  s_cbranch_vccz L_wfp2_out
  buffer_load_dword v12, v10, s[48:51], s78 offen sc1
  s_add_u32 s79, s79, 1
  s_cmp_gt_u32 s79, 0x40000
  s_cbranch_scc0 L_wfp2_poll
L_wfp2_out:
  s_mov_b64 exec, -1
L_p2_nopoll:
  s_barrier
  s_lshl_b32 s64, s36, 1
  s_or_b32 s64, s64, s67
  s_lshl_b32 s65, s63, 3
  s_add_u32 s64, s64, s65
  s_sub_u32 s64, s64, 8
  s_lshl_b32 s64, s64, 10
  s_lshl_b32 s65, s62, 16
  s_add_u32 s64, s64, s65
  s_add_u32 s65, s64, 2097152
  buffer_load_dwordx4 v[100:103], v2, s[48:51], s65 offen sc1
  s_add_u32 s65, s64, 4194304
  buffer_load_dwordx4 v[104:107], v2, s[48:51], s65 offen sc1
  s_lshl_b32 s64, s36, 1
  s_add_u32 s64, s64, 1
  s_or_b32 s64, s64, s67
  s_lshl_b32 s65, s63, 3
  s_add_u32 s64, s64, s65
  s_sub_u32 s64, s64, 8
  s_lshl_b32 s64, s64, 10
  s_lshl_b32 s65, s62, 16
  s_add_u32 s64, s64, s65
  s_add_u32 s65, s64, 2097152
  buffer_load_dwordx4 v[108:111], v2, s[48:51], s65 offen sc1
  s_add_u32 s65, s64, 4194304
  buffer_load_dwordx4 v[112:115], v2, s[48:51], s65 offen sc1
  s_lshl_b32 s68, s63, 3
  s_add_u32 s68, s68, s36
  s_lshl_b32 s64, s68, 10
  s_lshl_b32 s65, s62, 16
  s_add_u32 s64, s64, s65
  s_add_u32 s64, s64, 0
  buffer_load_dwordx4 v[12:15], v2, s[48:51], s64 offen sc1
  s_lshl_b32 s64, s36, 11
  v_add_u32 v4, s64, v2
  s_waitcnt vmcnt(0)
  ds_write_b128 v4, v[100:103] offset:0
  ds_write_b128 v4, v[104:107] offset:16384
  ds_write_b128 v4, v[108:111] offset:1024
  ds_write_b128 v4, v[112:115] offset:17408
  s_waitcnt lgkmcnt(0)
  s_barrier
  s_cmp_lt_u32 s36, 4
  s_cbranch_scc1 L_p2_nopf
  v_lshrrev_b32 v10, 4, v1
  s_mov_b32 s74, 3584
  v_mul_lo_u32 v10, v10, s74
  v_and_b32 v11, 15, v1
  v_min_u32 v11, 13, v11
  v_lshlrev_b32 v11, 7, v11
  v_add_u32 v10, v10, v11
  s_lshl_b32 s74, s39, 2
  s_add_u32 s74, s74, s57
  s_mul_i32 s74, s74, 14336
  s_mul_i32 s75, s38, 1792
  s_add_u32 s74, s74, s75
  s_mov_b32 s52, s24
  s_and_b32 s53, s25, 0xffff
  s_mov_b32 s54, 0x1c0000
  s_mov_b32 s55, 0x20000
  buffer_load_dword v228, v10, s[52:55], s74 offen
  s_mov_b32 s52, s26
  s_and_b32 s53, s27, 0xffff
  s_mov_b32 s54, 0x1c0000
  s_mov_b32 s55, 0x20000
  buffer_load_dword v228, v10, s[52:55], s74 offen
L_p2_nopf:
  ds_read_b128 v[40:43], v8 offset:0
  ds_read_b128 v[44:47], v8 offset:1024
  ds_read_b128 v[48:51], v8 offset:2048
  ds_read_b128 v[52:55], v8 offset:3072
  ds_read_b128 v[56:59], v8 offset:4096
  ds_read_b128 v[60:63], v8 offset:5120
  ds_read_b128 v[64:67], v8 offset:6144
  ds_read_b128 v[68:71], v8 offset:7168
  ds_read_b128 v[72:75], v8 offset:8192
  s_sub_u32 s69, 8, s36
  s_cmp_eq_u32 s67, 0
  s_cselect_b32 s69, 0xff, s69
  s_cselect_b32 s70, 0, 0xf149f2ca
  v_mov_b32 v164, s70
  v_mov_b32 v165, s70
  v_mov_b32 v166, s70
  v_mov_b32 v167, s70
  v_mov_b32 v168, s70
  v_mov_b32 v169, s70
  v_mov_b32 v170, s70
  v_mov_b32 v171, s70
  v_mov_b32 v172, s70
  v_mov_b32 v173, s70
  v_mov_b32 v174, s70
  v_mov_b32 v175, s70
  v_mov_b32 v176, s70
  v_mov_b32 v177, s70
  v_mov_b32 v178, s70
  v_mov_b32 v179, s70
  s_waitcnt lgkmcnt(0)
  s_mov_b64 exec, s[76:77]
  ds_read_b128 v[76:79], v9 offset:0
  ds_read_b128 v[80:83], v9 offset:512
  s_mov_b64 exec, -1
  v_mfma_f32_32x32x16_bf16 v[100:115], v[40:43], v[12:15], v[164:179]
  v_mfma_f32_32x32x16_bf16 v[116:131], v[72:75], v[12:15], 0
  s_cmp_lg_u32 s69, 1
  s_cbranch_scc1 L_sw1
  s_nop 3
  v_mov_b32 v164, 0
  s_nop 3
  v_mov_b32 v165, 0
  s_nop 3
  v_mov_b32 v166, 0
  s_nop 3
  v_mov_b32 v167, 0
  s_nop 3
  v_mov_b32 v168, 0
  s_nop 3
  v_mov_b32 v169, 0
  s_nop 3
  v_mov_b32 v170, 0
  s_nop 3
  v_mov_b32 v171, 0
  s_nop 3
  v_mov_b32 v172, 0
  s_nop 3
  v_mov_b32 v173, 0
  s_nop 3
  v_mov_b32 v174, 0
  s_nop 3
  v_mov_b32 v175, 0
  s_nop 3
  v_mov_b32 v176, 0
  s_nop 3
  v_mov_b32 v177, 0
  s_nop 3
  v_mov_b32 v178, 0
  s_nop 3
  v_mov_b32 v179, 0
L_sw1:
  s_nop 1
  v_mfma_f32_32x32x16_bf16 v[132:147], v[44:47], v[12:15], v[164:179]
  s_cmp_lg_u32 s69, 2
  s_cbranch_scc1 L_sw2
  s_nop 4
  v_mov_b32 v164, 0
  s_nop 4
  v_mov_b32 v165, 0
  s_nop 4
  v_mov_b32 v166, 0
  s_nop 4
  v_mov_b32 v167, 0
  s_nop 4
  v_mov_b32 v168, 0
  s_nop 4
  v_mov_b32 v169, 0
  s_nop 4
  v_mov_b32 v170, 0
  s_nop 4
  v_mov_b32 v171, 0
  s_nop 4
  v_mov_b32 v172, 0
  s_nop 4
  v_mov_b32 v173, 0
  s_nop 4
  v_mov_b32 v174, 0
  s_nop 4
  v_mov_b32 v175, 0
  s_nop 4
  v_mov_b32 v176, 0
  s_nop 4
  v_mov_b32 v177, 0
  s_nop 4
  v_mov_b32 v178, 0
  s_nop 4
  v_mov_b32 v179, 0
L_sw2:
  s_nop 1
  v_mfma_f32_32x32x16_bf16 v[148:163], v[48:51], v[12:15], v[164:179]
  s_mov_b64 exec, s[76:77]
  ds_read_b128 v[84:87], v9 offset:8192
  ds_read_b128 v[88:91], v9 offset:8704
  s_mov_b64 exec, -1
  v_bfi_b32 v116, v16, v100, v116
  v_bfi_b32 v117, v17, v101, v117
  v_bfi_b32 v118, v18, v102, v118
  v_bfi_b32 v119, v19, v103, v119
  v_bfi_b32 v120, v20, v104, v120
  v_bfi_b32 v121, v21, v105, v121
  v_bfi_b32 v122, v22, v106, v122
  v_bfi_b32 v123, v23, v107, v123
  v_bfi_b32 v124, v24, v108, v124
  v_bfi_b32 v125, v25, v109, v125
  v_bfi_b32 v126, v26, v110, v126
  v_bfi_b32 v127, v27, v111, v127
  v_bfi_b32 v128, v28, v112, v128
  v_bfi_b32 v129, v29, v113, v129
  v_bfi_b32 v130, v30, v114, v130
  v_bfi_b32 v131, v31, v115, v131
  v_exp_f32 v116, v116
  v_exp_f32 v117, v117
  v_exp_f32 v118, v118
  v_exp_f32 v119, v119
  v_cvt_pk_bf16_f32 v196, v116, v117
  v_exp_f32 v120, v120
  v_exp_f32 v121, v121
  v_cvt_pk_bf16_f32 v197, v118, v119
  v_exp_f32 v122, v122
  v_exp_f32 v123, v123
  v_cvt_pk_bf16_f32 v198, v120, v121
  v_exp_f32 v124, v124
  v_exp_f32 v125, v125
  v_cvt_pk_bf16_f32 v199, v122, v123
  v_exp_f32 v126, v126
  v_exp_f32 v127, v127
  v_cvt_pk_bf16_f32 v200, v124, v125
  v_exp_f32 v128, v128
  v_exp_f32 v129, v129
  v_cvt_pk_bf16_f32 v201, v126, v127
  v_exp_f32 v130, v130
  v_exp_f32 v131, v131
  v_cvt_pk_bf16_f32 v202, v128, v129
  v_cvt_pk_bf16_f32 v203, v130, v131
  v_and_b32 v204, v32, v196
  v_bfi_b32 v196, v32, 0, v196
  v_and_b32 v205, v33, v197
  v_bfi_b32 v197, v33, 0, v197
  v_and_b32 v206, v34, v198
  v_bfi_b32 v198, v34, 0, v198
  v_and_b32 v207, v35, v199
  v_bfi_b32 v199, v35, 0, v199
  v_and_b32 v208, v36, v200
  v_bfi_b32 v200, v36, 0, v200
  v_and_b32 v209, v37, v201
  v_bfi_b32 v201, v37, 0, v201
  v_and_b32 v210, v38, v202
  v_bfi_b32 v202, v38, 0, v202
  v_and_b32 v211, v39, v203
  v_bfi_b32 v203, v39, 0, v203
  s_mov_b64 exec, s[76:77]
  ds_read_b128 v[92:95], v9 offset:1024
  ds_read_b128 v[96:99], v9 offset:1536
  s_mov_b64 exec, -1
  s_waitcnt lgkmcnt(2)
  v_exp_f32 v132, v132
  v_exp_f32 v133, v133
  s_cmp_lg_u32 s69, 3
  s_cbranch_scc1 L_sw3
  v_mov_b32 v164, 0
  v_mov_b32 v165, 0
  v_mov_b32 v166, 0
  v_mov_b32 v167, 0
  v_mov_b32 v168, 0
  v_mov_b32 v169, 0
  v_mov_b32 v170, 0
  v_mov_b32 v171, 0
  v_mov_b32 v172, 0
  v_mov_b32 v173, 0
  v_mov_b32 v174, 0
  v_mov_b32 v175, 0
  v_mov_b32 v176, 0
  v_mov_b32 v177, 0
  v_mov_b32 v178, 0
  v_mov_b32 v179, 0
L_sw3:
  s_nop 1
  v_mfma_f32_32x32x16_bf16 v[100:115], v[52:55], v[12:15], v[164:179]
  v_exp_f32 v134, v134
  v_exp_f32 v135, v135
  v_cvt_pk_bf16_f32 v212, v132, v133
  v_exp_f32 v136, v136
  v_exp_f32 v137, v137
  v_cvt_pk_bf16_f32 v213, v134, v135
  v_mfma_f32_32x32x16_bf16 v[180:195], v[76:79], v[204:207], 0
  v_exp_f32 v138, v138
  v_exp_f32 v139, v139
  v_cvt_pk_bf16_f32 v214, v136, v137
  v_exp_f32 v140, v140
  v_exp_f32 v141, v141
  v_cvt_pk_bf16_f32 v215, v138, v139
  v_mfma_f32_32x32x16_bf16 v[180:195], v[80:83], v[208:211], v[180:195]
  v_exp_f32 v142, v142
  v_exp_f32 v143, v143
  v_cvt_pk_bf16_f32 v216, v140, v141
  v_exp_f32 v144, v144
  v_exp_f32 v145, v145
  v_cvt_pk_bf16_f32 v217, v142, v143
  v_mfma_f32_32x32x16_bf16 v[180:195], v[84:87], v[196:199], v[180:195]
  v_exp_f32 v146, v146
  v_exp_f32 v147, v147
  v_cvt_pk_bf16_f32 v218, v144, v145
  v_mfma_f32_32x32x16_bf16 v[180:195], v[88:91], v[200:203], v[180:195]
  v_cvt_pk_bf16_f32 v219, v146, v147
  s_mov_b64 exec, s[76:77]
  ds_read_b128 v[76:79], v9 offset:2048
  ds_read_b128 v[80:83], v9 offset:2560
  s_mov_b64 exec, -1
  s_waitcnt lgkmcnt(2)
  v_exp_f32 v148, v148
  v_exp_f32 v149, v149
  v_exp_f32 v150, v150
  v_exp_f32 v151, v151
  v_cvt_pk_bf16_f32 v204, v148, v149
  s_cmp_lg_u32 s69, 4
  s_cbranch_scc1 L_sw4
  v_mov_b32 v164, 0
  v_mov_b32 v165, 0
  v_mov_b32 v166, 0
  v_mov_b32 v167, 0
  v_mov_b32 v168, 0
  v_mov_b32 v169, 0
  v_mov_b32 v170, 0
  v_mov_b32 v171, 0
  v_mov_b32 v172, 0
  v_mov_b32 v173, 0
  v_mov_b32 v174, 0
  v_mov_b32 v175, 0
  v_mov_b32 v176, 0
  v_mov_b32 v177, 0
  v_mov_b32 v178, 0
  v_mov_b32 v179, 0
L_sw4:
  s_nop 1
  v_mfma_f32_32x32x16_bf16 v[116:131], v[56:59], v[12:15], v[164:179]
  v_exp_f32 v152, v152
  v_exp_f32 v153, v153
  v_cvt_pk_bf16_f32 v205, v150, v151
  v_exp_f32 v154, v154
  v_exp_f32 v155, v155
  v_cvt_pk_bf16_f32 v206, v152, v153
  v_mfma_f32_32x32x16_bf16 v[180:195], v[92:95], v[212:215], v[180:195]
  v_exp_f32 v156, v156
  v_exp_f32 v157, v157
  v_cvt_pk_bf16_f32 v207, v154, v155
  v_exp_f32 v158, v158
  v_exp_f32 v159, v159
  v_cvt_pk_bf16_f32 v208, v156, v157
  v_mfma_f32_32x32x16_bf16 v[180:195], v[96:99], v[216:219], v[180:195]
  v_exp_f32 v160, v160
  v_exp_f32 v161, v161
  v_cvt_pk_bf16_f32 v209, v158, v159
  v_exp_f32 v162, v162
  v_exp_f32 v163, v163
  v_cvt_pk_bf16_f32 v210, v160, v161
  v_cvt_pk_bf16_f32 v211, v162, v163
  s_mov_b64 exec, s[76:77]
  ds_read_b128 v[84:87], v9 offset:3072
  ds_read_b128 v[88:91], v9 offset:3584
  s_mov_b64 exec, -1
  s_waitcnt lgkmcnt(2)
  v_exp_f32 v100, v100
  v_exp_f32 v101, v101
  v_exp_f32 v102, v102
  v_exp_f32 v103, v103
  v_cvt_pk_bf16_f32 v196, v100, v101
  s_cmp_lg_u32 s69, 5
  s_cbranch_scc1 L_sw5
  v_mov_b32 v164, 0
  v_mov_b32 v165, 0
  v_mov_b32 v166, 0
  v_mov_b32 v167, 0
  v_mov_b32 v168, 0
  v_mov_b32 v169, 0
  v_mov_b32 v170, 0
  v_mov_b32 v171, 0
  v_mov_b32 v172, 0
  v_mov_b32 v173, 0
  v_mov_b32 v174, 0
  v_mov_b32 v175, 0
  v_mov_b32 v176, 0
  v_mov_b32 v177, 0
  v_mov_b32 v178, 0
  v_mov_b32 v179, 0
L_sw5:
  s_nop 1
  v_mfma_f32_32x32x16_bf16 v[132:147], v[60:63], v[12:15], v[164:179]
  v_exp_f32 v104, v104
  v_exp_f32 v105, v105
  v_cvt_pk_bf16_f32 v197, v102, v103
  v_exp_f32 v106, v106
  v_exp_f32 v107, v107
  v_cvt_pk_bf16_f32 v198, v104, v105
  v_mfma_f32_32x32x16_bf16 v[180:195], v[76:79], v[204:207], v[180:195]
  v_exp_f32 v108, v108
  v_exp_f32 v109, v109
  v_cvt_pk_bf16_f32 v199, v106, v107
  v_exp_f32 v110, v110
  v_exp_f32 v111, v111
  v_cvt_pk_bf16_f32 v200, v108, v109
  v_mfma_f32_32x32x16_bf16 v[180:195], v[80:83], v[208:211], v[180:195]
  v_exp_f32 v112, v112
  v_exp_f32 v113, v113
  v_cvt_pk_bf16_f32 v201, v110, v111
  v_exp_f32 v114, v114
  v_exp_f32 v115, v115
  v_cvt_pk_bf16_f32 v202, v112, v113
  v_cvt_pk_bf16_f32 v203, v114, v115
  s_mov_b64 exec, s[76:77]
  ds_read_b128 v[92:95], v9 offset:4096
  ds_read_b128 v[96:99], v9 offset:4608
  s_mov_b64 exec, -1
  s_waitcnt lgkmcnt(2)
  v_exp_f32 v116, v116
  v_exp_f32 v117, v117
  v_exp_f32 v118, v118
  v_exp_f32 v119, v119
  v_cvt_pk_bf16_f32 v212, v116, v117
  s_cmp_lg_u32 s69, 6
  s_cbranch_scc1 L_sw6
  v_mov_b32 v164, 0
  v_mov_b32 v165, 0
  v_mov_b32 v166, 0
  v_mov_b32 v167, 0
  v_mov_b32 v168, 0
  v_mov_b32 v169, 0
  v_mov_b32 v170, 0
  v_mov_b32 v171, 0
  v_mov_b32 v172, 0
  v_mov_b32 v173, 0
  v_mov_b32 v174, 0
  v_mov_b32 v175, 0
  v_mov_b32 v176, 0
  v_mov_b32 v177, 0
  v_mov_b32 v178, 0
  v_mov_b32 v179, 0
L_sw6:
  s_nop 1
  v_mfma_f32_32x32x16_bf16 v[148:163], v[64:67], v[12:15], v[164:179]
  v_exp_f32 v120, v120
  v_exp_f32 v121, v121
  v_cvt_pk_bf16_f32 v213, v118, v119
  v_exp_f32 v122, v122
  v_exp_f32 v123, v123
  v_cvt_pk_bf16_f32 v214, v120, v121
  v_mfma_f32_32x32x16_bf16 v[180:195], v[84:87], v[196:199], v[180:195]
  v_exp_f32 v124, v124
  v_exp_f32 v125, v125
  v_cvt_pk_bf16_f32 v215, v122, v123
  v_exp_f32 v126, v126
  v_exp_f32 v127, v127
  v_cvt_pk_bf16_f32 v216, v124, v125
  v_mfma_f32_32x32x16_bf16 v[180:195], v[88:91], v[200:203], v[180:195]
  v_exp_f32 v128, v128
  v_exp_f32 v129, v129
  v_cvt_pk_bf16_f32 v217, v126, v127
  v_exp_f32 v130, v130
  v_exp_f32 v131, v131
  v_cvt_pk_bf16_f32 v218, v128, v129
  v_cvt_pk_bf16_f32 v219, v130, v131
  s_mov_b64 exec, s[76:77]
  ds_read_b128 v[76:79], v9 offset:5120
  ds_read_b128 v[80:83], v9 offset:5632
  s_mov_b64 exec, -1
  s_waitcnt lgkmcnt(2)
  v_exp_f32 v132, v132
  v_exp_f32 v133, v133
  v_exp_f32 v134, v134
  v_exp_f32 v135, v135
  v_cvt_pk_bf16_f32 v204, v132, v133
  s_cmp_lg_u32 s69, 7
  s_cbranch_scc1 L_sw7
  v_mov_b32 v164, 0
  v_mov_b32 v165, 0
  v_mov_b32 v166, 0
  v_mov_b32 v167, 0
  v_mov_b32 v168, 0
  v_mov_b32 v169, 0
  v_mov_b32 v170, 0
  v_mov_b32 v171, 0
  v_mov_b32 v172, 0
  v_mov_b32 v173, 0
  v_mov_b32 v174, 0
  v_mov_b32 v175, 0
  v_mov_b32 v176, 0
  v_mov_b32 v177, 0
  v_mov_b32 v178, 0
  v_mov_b32 v179, 0
L_sw7:
  s_nop 1
  v_mfma_f32_32x32x16_bf16 v[100:115], v[68:71], v[12:15], v[164:179]
  v_exp_f32 v136, v136
  v_exp_f32 v137, v137
  v_cvt_pk_bf16_f32 v205, v134, v135
  v_exp_f32 v138, v138
  v_exp_f32 v139, v139
  v_cvt_pk_bf16_f32 v206, v136, v137
  v_mfma_f32_32x32x16_bf16 v[180:195], v[92:95], v[212:215], v[180:195]
  v_exp_f32 v140, v140
  v_exp_f32 v141, v141
  v_cvt_pk_bf16_f32 v207, v138, v139
  v_exp_f32 v142, v142
  v_exp_f32 v143, v143
  v_cvt_pk_bf16_f32 v208, v140, v141
  v_mfma_f32_32x32x16_bf16 v[180:195], v[96:99], v[216:219], v[180:195]
  v_exp_f32 v144, v144
  v_exp_f32 v145, v145
  v_cvt_pk_bf16_f32 v209, v142, v143
  v_exp_f32 v146, v146
  v_exp_f32 v147, v147
  v_cvt_pk_bf16_f32 v210, v144, v145
  v_cvt_pk_bf16_f32 v211, v146, v147
  s_mov_b64 exec, s[76:77]
  ds_read_b128 v[84:87], v9 offset:6144
  ds_read_b128 v[88:91], v9 offset:6656
  s_mov_b64 exec, -1
  s_waitcnt lgkmcnt(2)
  v_exp_f32 v148, v148
  v_exp_f32 v149, v149
  v_exp_f32 v150, v150
  v_exp_f32 v151, v151
  v_cvt_pk_bf16_f32 v196, v148, v149
  v_mfma_f32_32x32x16_bf16 v[180:195], v[76:79], v[204:207], v[180:195]
  v_exp_f32 v152, v152
  v_exp_f32 v153, v153
  v_cvt_pk_bf16_f32 v197, v150, v151
  v_exp_f32 v154, v154
  v_exp_f32 v155, v155
  v_cvt_pk_bf16_f32 v198, v152, v153
  v_mfma_f32_32x32x16_bf16 v[180:195], v[80:83], v[208:211], v[180:195]
  v_exp_f32 v156, v156
  v_exp_f32 v157, v157
  v_cvt_pk_bf16_f32 v199, v154, v155
  v_exp_f32 v158, v158
  v_exp_f32 v159, v159
  v_cvt_pk_bf16_f32 v200, v156, v157
  v_exp_f32 v160, v160
  v_exp_f32 v161, v161
  v_cvt_pk_bf16_f32 v201, v158, v159
  v_exp_f32 v162, v162
  v_exp_f32 v163, v163
  v_cvt_pk_bf16_f32 v202, v160, v161
  v_cvt_pk_bf16_f32 v203, v162, v163
  s_mov_b64 exec, s[76:77]
  ds_read_b128 v[92:95], v9 offset:7168
  ds_read_b128 v[96:99], v9 offset:7680
  s_mov_b64 exec, -1
  s_waitcnt lgkmcnt(2)
  v_exp_f32 v100, v100
  v_exp_f32 v101, v101
  v_exp_f32 v102, v102
  v_exp_f32 v103, v103
  v_cvt_pk_bf16_f32 v212, v100, v101
  v_mfma_f32_32x32x16_bf16 v[180:195], v[84:87], v[196:199], v[180:195]
  v_exp_f32 v104, v104
  v_exp_f32 v105, v105
  v_cvt_pk_bf16_f32 v213, v102, v103
  v_exp_f32 v106, v106
  v_exp_f32 v107, v107
  v_cvt_pk_bf16_f32 v214, v104, v105
  v_mfma_f32_32x32x16_bf16 v[180:195], v[88:91], v[200:203], v[180:195]
  v_exp_f32 v108, v108
  v_exp_f32 v109, v109
  v_cvt_pk_bf16_f32 v215, v106, v107
  v_exp_f32 v110, v110
  v_exp_f32 v111, v111
  v_cvt_pk_bf16_f32 v216, v108, v109
  v_exp_f32 v112, v112
  v_exp_f32 v113, v113
  v_cvt_pk_bf16_f32 v217, v110, v111
  v_exp_f32 v114, v114
  v_exp_f32 v115, v115
  v_cvt_pk_bf16_f32 v218, v112, v113
  v_cvt_pk_bf16_f32 v219, v114, v115
  s_waitcnt lgkmcnt(0)
  v_mfma_f32_32x32x16_bf16 v[180:195], v[92:95], v[212:215], v[180:195]
  v_mfma_f32_32x32x16_bf16 v[180:195], v[96:99], v[216:219], v[180:195]
  s_mov_b32 s70, 0x21800000
  s_mov_b32 s71, 0x53800000
  s_nop 9
  v_cmp_nle_f32 vcc, s70, v188
  v_cmp_nge_f32 s[72:73], s71, v188
  s_nop 1
  s_or_b64 s[72:73], vcc, s[72:73]
  s_cbranch_scc0 L_p2_fin
  s_nop 0
  s_cmp_eq_u32 s67, 0
  s_cbranch_scc0 L_p2_generic
  v_mfma_f32_32x32x16_bf16 v[100:115], v[40:43], v[12:15], 0
  v_mfma_f32_32x32x16_bf16 v[116:131], v[72:75], v[12:15], 0
  v_mfma_f32_32x32x16_bf16 v[132:147], v[44:47], v[12:15], 0
  v_mfma_f32_32x32x16_bf16 v[148:163], v[48:51], v[12:15], 0
  s_mov_b64 exec, s[76:77]
  ds_read_b128 v[76:79], v9 offset:0
  ds_read_b128 v[80:83], v9 offset:512
  s_mov_b64 exec, -1
  s_nop 5
  v_bfi_b32 v116, v16, v100, v116
  v_bfi_b32 v117, v17, v101, v117
  v_bfi_b32 v118, v18, v102, v118
  v_bfi_b32 v119, v19, v103, v119
  v_bfi_b32 v120, v20, v104, v120
  v_bfi_b32 v121, v21, v105, v121
  v_bfi_b32 v122, v22, v106, v122
  v_bfi_b32 v123, v23, v107, v123
  v_bfi_b32 v124, v24, v108, v124
  v_bfi_b32 v125, v25, v109, v125
  v_bfi_b32 v126, v26, v110, v126
  v_bfi_b32 v127, v27, v111, v127
  v_bfi_b32 v128, v28, v112, v128
  v_bfi_b32 v129, v29, v113, v129
  v_bfi_b32 v130, v30, v114, v130
  v_bfi_b32 v131, v31, v115, v131
  v_max_f32 v7, v116, v117
  v_max_f32 v10, v118, v119
  v_max3_f32 v7, v120, v121, v7
  v_max3_f32 v10, v122, v123, v10
  v_max3_f32 v7, v124, v125, v7
  v_max3_f32 v10, v126, v127, v10
  v_max3_f32 v7, v128, v129, v7
  v_max3_f32 v10, v130, v131, v10
  v_max3_f32 v7, v132, v133, v7
  v_max3_f32 v10, v134, v135, v10
  v_max3_f32 v7, v136, v137, v7
  v_max3_f32 v10, v138, v139, v10
  v_mfma_f32_32x32x16_bf16 v[100:115], v[52:55], v[12:15], 0
  v_max3_f32 v7, v140, v141, v7
  v_max3_f32 v10, v142, v143, v10
  v_max3_f32 v7, v144, v145, v7
  v_max3_f32 v10, v146, v147, v10
  v_max3_f32 v7, v148, v149, v7
  v_max3_f32 v10, v150, v151, v10
  v_max3_f32 v7, v152, v153, v7
  v_max3_f32 v10, v154, v155, v10
  v_mfma_f32_32x32x16_bf16 v[116:131], v[56:59], v[12:15], 0
  v_max3_f32 v7, v156, v157, v7
  v_max3_f32 v10, v158, v159, v10
  v_max3_f32 v7, v160, v161, v7
  v_max3_f32 v10, v162, v163, v10
  v_max3_f32 v7, v100, v101, v7
  v_max3_f32 v10, v102, v103, v10
  v_max3_f32 v7, v104, v105, v7
  v_max3_f32 v10, v106, v107, v10
  v_mfma_f32_32x32x16_bf16 v[132:147], v[60:63], v[12:15], 0
  v_max3_f32 v7, v108, v109, v7
  v_max3_f32 v10, v110, v111, v10
  v_max3_f32 v7, v112, v113, v7
  v_max3_f32 v10, v114, v115, v10
  v_max3_f32 v7, v116, v117, v7
  v_max3_f32 v10, v118, v119, v10
  v_max3_f32 v7, v120, v121, v7
  v_max3_f32 v10, v122, v123, v10
  v_mfma_f32_32x32x16_bf16 v[148:163], v[64:67], v[12:15], 0
  v_max3_f32 v7, v124, v125, v7
  v_max3_f32 v10, v126, v127, v10
  v_max3_f32 v7, v128, v129, v7
  v_max3_f32 v10, v130, v131, v10
  v_max3_f32 v7, v132, v133, v7
  v_max3_f32 v10, v134, v135, v10
  v_max3_f32 v7, v136, v137, v7
  v_max3_f32 v10, v138, v139, v10
  v_mfma_f32_32x32x16_bf16 v[100:115], v[68:71], v[12:15], 0
  v_max3_f32 v7, v140, v141, v7
  v_max3_f32 v10, v142, v143, v10
  v_max3_f32 v7, v144, v145, v7
  v_max3_f32 v10, v146, v147, v10
  v_max3_f32 v7, v148, v149, v7
  v_max3_f32 v10, v150, v151, v10
  v_max3_f32 v7, v152, v153, v7
  v_max3_f32 v10, v154, v155, v10
  v_max3_f32 v7, v156, v157, v7
  v_max3_f32 v10, v158, v159, v10
  v_max3_f32 v7, v160, v161, v7
  v_max3_f32 v10, v162, v163, v10
  v_max3_f32 v7, v100, v101, v7
  v_max3_f32 v10, v102, v103, v10
  v_max3_f32 v7, v104, v105, v7
  v_max3_f32 v10, v106, v107, v10
  v_max3_f32 v7, v108, v109, v7
  v_max3_f32 v10, v110, v111, v10
  v_max3_f32 v7, v112, v113, v7
  v_max3_f32 v10, v114, v115, v10
  v_max_f32 v7, v7, v10
  v_mov_b32 v4, v7
  s_nop 1
  v_permlane32_swap_b32 v4, v7
  v_max_f32 v7, v4, v7
  v_sub_f32 v164, 0, v7
  v_sub_f32 v165, 0, v7
  v_sub_f32 v166, 0, v7
  v_sub_f32 v167, 0, v7
  v_sub_f32 v168, 0, v7
  v_sub_f32 v169, 0, v7
  v_sub_f32 v170, 0, v7
  v_sub_f32 v171, 0, v7
  v_sub_f32 v172, 0, v7
  v_sub_f32 v173, 0, v7
  v_sub_f32 v174, 0, v7
  v_sub_f32 v175, 0, v7
  v_sub_f32 v176, 0, v7
  v_sub_f32 v177, 0, v7
  v_sub_f32 v178, 0, v7
  v_sub_f32 v179, 0, v7
  s_nop 1
  v_mfma_f32_32x32x16_bf16 v[100:115], v[40:43], v[12:15], v[164:179]
  v_mfma_f32_32x32x16_bf16 v[116:131], v[72:75], v[12:15], v[164:179]
  v_mfma_f32_32x32x16_bf16 v[132:147], v[44:47], v[12:15], v[164:179]
  v_mfma_f32_32x32x16_bf16 v[148:163], v[48:51], v[12:15], v[164:179]
  s_mov_b64 exec, s[76:77]
  ds_read_b128 v[84:87], v9 offset:8192
  ds_read_b128 v[88:91], v9 offset:8704
  s_mov_b64 exec, -1
  s_nop 5
  v_bfi_b32 v116, v16, v100, v116
  v_bfi_b32 v117, v17, v101, v117
  v_bfi_b32 v118, v18, v102, v118
  v_bfi_b32 v119, v19, v103, v119
  v_bfi_b32 v120, v20, v104, v120
  v_bfi_b32 v121, v21, v105, v121
  v_bfi_b32 v122, v22, v106, v122
  v_bfi_b32 v123, v23, v107, v123
  v_bfi_b32 v124, v24, v108, v124
  v_bfi_b32 v125, v25, v109, v125
  v_bfi_b32 v126, v26, v110, v126
  v_bfi_b32 v127, v27, v111, v127
  v_bfi_b32 v128, v28, v112, v128
  v_bfi_b32 v129, v29, v113, v129
  v_bfi_b32 v130, v30, v114, v130
  v_bfi_b32 v131, v31, v115, v131
  v_exp_f32 v116, v116
  v_exp_f32 v117, v117
  v_exp_f32 v118, v118
  v_exp_f32 v119, v119
  v_cvt_pk_bf16_f32 v196, v116, v117
  v_exp_f32 v120, v120
  v_exp_f32 v121, v121
  v_cvt_pk_bf16_f32 v197, v118, v119
  v_exp_f32 v122, v122
  v_exp_f32 v123, v123
  v_cvt_pk_bf16_f32 v198, v120, v121
  v_exp_f32 v124, v124
  v_exp_f32 v125, v125
  v_cvt_pk_bf16_f32 v199, v122, v123
  v_exp_f32 v126, v126
  v_exp_f32 v127, v127
  v_cvt_pk_bf16_f32 v200, v124, v125
  v_exp_f32 v128, v128
  v_exp_f32 v129, v129
  v_cvt_pk_bf16_f32 v201, v126, v127
  v_exp_f32 v130, v130
  v_exp_f32 v131, v131
  v_cvt_pk_bf16_f32 v202, v128, v129
  v_cvt_pk_bf16_f32 v203, v130, v131
  v_and_b32 v204, v32, v196
  v_bfi_b32 v196, v32, 0, v196
  v_and_b32 v205, v33, v197
  v_bfi_b32 v197, v33, 0, v197
  v_and_b32 v206, v34, v198
  v_bfi_b32 v198, v34, 0, v198
  v_and_b32 v207, v35, v199
  v_bfi_b32 v199, v35, 0, v199
  v_and_b32 v208, v36, v200
  v_bfi_b32 v200, v36, 0, v200
  v_and_b32 v209, v37, v201
  v_bfi_b32 v201, v37, 0, v201
  v_and_b32 v210, v38, v202
  v_bfi_b32 v202, v38, 0, v202
  v_and_b32 v211, v39, v203
  v_bfi_b32 v203, v39, 0, v203
  s_mov_b64 exec, s[76:77]
  ds_read_b128 v[92:95], v9 offset:1024
  ds_read_b128 v[96:99], v9 offset:1536
  s_mov_b64 exec, -1
  s_waitcnt lgkmcnt(2)
  v_exp_f32 v132, v132
  v_exp_f32 v133, v133
  v_mfma_f32_32x32x16_bf16 v[100:115], v[52:55], v[12:15], v[164:179]
  v_exp_f32 v134, v134
  v_exp_f32 v135, v135
  v_cvt_pk_bf16_f32 v212, v132, v133
  v_exp_f32 v136, v136
  v_exp_f32 v137, v137
  v_cvt_pk_bf16_f32 v213, v134, v135
  v_mfma_f32_32x32x16_bf16 v[180:195], v[76:79], v[204:207], 0
  v_exp_f32 v138, v138
  v_exp_f32 v139, v139
  v_cvt_pk_bf16_f32 v214, v136, v137
  v_exp_f32 v140, v140
  v_exp_f32 v141, v141
  v_cvt_pk_bf16_f32 v215, v138, v139
  v_mfma_f32_32x32x16_bf16 v[180:195], v[80:83], v[208:211], v[180:195]
  v_exp_f32 v142, v142
  v_exp_f32 v143, v143
  v_cvt_pk_bf16_f32 v216, v140, v141
  v_exp_f32 v144, v144
  v_exp_f32 v145, v145
  v_cvt_pk_bf16_f32 v217, v142, v143
  v_mfma_f32_32x32x16_bf16 v[180:195], v[84:87], v[196:199], v[180:195]
  v_exp_f32 v146, v146
  v_exp_f32 v147, v147
  v_cvt_pk_bf16_f32 v218, v144, v145
  v_mfma_f32_32x32x16_bf16 v[180:195], v[88:91], v[200:203], v[180:195]
  v_cvt_pk_bf16_f32 v219, v146, v147
  s_mov_b64 exec, s[76:77]
  ds_read_b128 v[76:79], v9 offset:2048
  ds_read_b128 v[80:83], v9 offset:2560
  s_mov_b64 exec, -1
  s_waitcnt lgkmcnt(2)
  v_exp_f32 v148, v148
  v_exp_f32 v149, v149
  v_exp_f32 v150, v150
  v_exp_f32 v151, v151
  v_cvt_pk_bf16_f32 v204, v148, v149
  v_mfma_f32_32x32x16_bf16 v[116:131], v[56:59], v[12:15], v[164:179]
  v_exp_f32 v152, v152
  v_exp_f32 v153, v153
  v_cvt_pk_bf16_f32 v205, v150, v151
  v_exp_f32 v154, v154
  v_exp_f32 v155, v155
  v_cvt_pk_bf16_f32 v206, v152, v153
  v_mfma_f32_32x32x16_bf16 v[180:195], v[92:95], v[212:215], v[180:195]
  v_exp_f32 v156, v156
  v_exp_f32 v157, v157
  v_cvt_pk_bf16_f32 v207, v154, v155
  v_exp_f32 v158, v158
  v_exp_f32 v159, v159
  v_cvt_pk_bf16_f32 v208, v156, v157
  v_mfma_f32_32x32x16_bf16 v[180:195], v[96:99], v[216:219], v[180:195]
  v_exp_f32 v160, v160
  v_exp_f32 v161, v161
  v_cvt_pk_bf16_f32 v209, v158, v159
  v_exp_f32 v162, v162
  v_exp_f32 v163, v163
  v_cvt_pk_bf16_f32 v210, v160, v161
  v_cvt_pk_bf16_f32 v211, v162, v163
  s_mov_b64 exec, s[76:77]
  ds_read_b128 v[84:87], v9 offset:3072
  ds_read_b128 v[88:91], v9 offset:3584
  s_mov_b64 exec, -1
  s_waitcnt lgkmcnt(2)
  v_exp_f32 v100, v100
  v_exp_f32 v101, v101
  v_exp_f32 v102, v102
  v_exp_f32 v103, v103
  v_cvt_pk_bf16_f32 v196, v100, v101
  v_mfma_f32_32x32x16_bf16 v[132:147], v[60:63], v[12:15], v[164:179]
  v_exp_f32 v104, v104
  v_exp_f32 v105, v105
  v_cvt_pk_bf16_f32 v197, v102, v103
  v_exp_f32 v106, v106
  v_exp_f32 v107, v107
  v_cvt_pk_bf16_f32 v198, v104, v105
  v_mfma_f32_32x32x16_bf16 v[180:195], v[76:79], v[204:207], v[180:195]
  v_exp_f32 v108, v108
  v_exp_f32 v109, v109
  v_cvt_pk_bf16_f32 v199, v106, v107
  v_exp_f32 v110, v110
  v_exp_f32 v111, v111
  v_cvt_pk_bf16_f32 v200, v108, v109
  v_mfma_f32_32x32x16_bf16 v[180:195], v[80:83], v[208:211], v[180:195]
  v_exp_f32 v112, v112
  v_exp_f32 v113, v113
  v_cvt_pk_bf16_f32 v201, v110, v111
  v_exp_f32 v114, v114
  v_exp_f32 v115, v115
  v_cvt_pk_bf16_f32 v202, v112, v113
  v_cvt_pk_bf16_f32 v203, v114, v115
  s_mov_b64 exec, s[76:77]
  ds_read_b128 v[92:95], v9 offset:4096
  ds_read_b128 v[96:99], v9 offset:4608
  s_mov_b64 exec, -1
  s_waitcnt lgkmcnt(2)
  v_exp_f32 v116, v116
  v_exp_f32 v117, v117
  v_exp_f32 v118, v118
  v_exp_f32 v119, v119
  v_cvt_pk_bf16_f32 v212, v116, v117
  v_mfma_f32_32x32x16_bf16 v[148:163], v[64:67], v[12:15], v[164:179]
  v_exp_f32 v120, v120
  v_exp_f32 v121, v121
  v_cvt_pk_bf16_f32 v213, v118, v119
  v_exp_f32 v122, v122
  v_exp_f32 v123, v123
  v_cvt_pk_bf16_f32 v214, v120, v121
  v_mfma_f32_32x32x16_bf16 v[180:195], v[84:87], v[196:199], v[180:195]
  v_exp_f32 v124, v124
  v_exp_f32 v125, v125
  v_cvt_pk_bf16_f32 v215, v122, v123
  v_exp_f32 v126, v126
  v_exp_f32 v127, v127
  v_cvt_pk_bf16_f32 v216, v124, v125
  v_mfma_f32_32x32x16_bf16 v[180:195], v[88:91], v[200:203], v[180:195]
  v_exp_f32 v128, v128
  v_exp_f32 v129, v129
  v_cvt_pk_bf16_f32 v217, v126, v127
  v_exp_f32 v130, v130
  v_exp_f32 v131, v131
  v_cvt_pk_bf16_f32 v218, v128, v129
  v_cvt_pk_bf16_f32 v219, v130, v131
  s_mov_b64 exec, s[76:77]
  ds_read_b128 v[76:79], v9 offset:5120
  ds_read_b128 v[80:83], v9 offset:5632
  s_mov_b64 exec, -1
  s_waitcnt lgkmcnt(2)
  v_exp_f32 v132, v132
  v_exp_f32 v133, v133
  v_exp_f32 v134, v134
  v_exp_f32 v135, v135
  v_cvt_pk_bf16_f32 v204, v132, v133
  v_mfma_f32_32x32x16_bf16 v[100:115], v[68:71], v[12:15], v[164:179]
  v_exp_f32 v136, v136
  v_exp_f32 v137, v137
  v_cvt_pk_bf16_f32 v205, v134, v135
  v_exp_f32 v138, v138
  v_exp_f32 v139, v139
  v_cvt_pk_bf16_f32 v206, v136, v137
  v_mfma_f32_32x32x16_bf16 v[180:195], v[92:95], v[212:215], v[180:195]
  v_exp_f32 v140, v140
  v_exp_f32 v141, v141
  v_cvt_pk_bf16_f32 v207, v138, v139
  v_exp_f32 v142, v142
  v_exp_f32 v143, v143
  v_cvt_pk_bf16_f32 v208, v140, v141
  v_mfma_f32_32x32x16_bf16 v[180:195], v[96:99], v[216:219], v[180:195]
  v_exp_f32 v144, v144
  v_exp_f32 v145, v145
  v_cvt_pk_bf16_f32 v209, v142, v143
  v_exp_f32 v146, v146
  v_exp_f32 v147, v147
  v_cvt_pk_bf16_f32 v210, v144, v145
  v_cvt_pk_bf16_f32 v211, v146, v147
  s_mov_b64 exec, s[76:77]
  ds_read_b128 v[84:87], v9 offset:6144
  ds_read_b128 v[88:91], v9 offset:6656
  s_mov_b64 exec, -1
  s_waitcnt lgkmcnt(2)
  v_exp_f32 v148, v148
  v_exp_f32 v149, v149
  v_exp_f32 v150, v150
  v_exp_f32 v151, v151
  v_cvt_pk_bf16_f32 v196, v148, v149
  v_mfma_f32_32x32x16_bf16 v[180:195], v[76:79], v[204:207], v[180:195]
  v_exp_f32 v152, v152
  v_exp_f32 v153, v153
  v_cvt_pk_bf16_f32 v197, v150, v151
  v_exp_f32 v154, v154
  v_exp_f32 v155, v155
  v_cvt_pk_bf16_f32 v198, v152, v153
  v_mfma_f32_32x32x16_bf16 v[180:195], v[80:83], v[208:211], v[180:195]
  v_exp_f32 v156, v156
  v_exp_f32 v157, v157
  v_cvt_pk_bf16_f32 v199, v154, v155
  v_exp_f32 v158, v158
  v_exp_f32 v159, v159
  v_cvt_pk_bf16_f32 v200, v156, v157
  v_exp_f32 v160, v160
  v_exp_f32 v161, v161
  v_cvt_pk_bf16_f32 v201, v158, v159
  v_exp_f32 v162, v162
  v_exp_f32 v163, v163
  v_cvt_pk_bf16_f32 v202, v160, v161
  v_cvt_pk_bf16_f32 v203, v162, v163
  s_mov_b64 exec, s[76:77]
  ds_read_b128 v[92:95], v9 offset:7168
  ds_read_b128 v[96:99], v9 offset:7680
  s_mov_b64 exec, -1
  s_waitcnt lgkmcnt(2)
  v_exp_f32 v100, v100
  v_exp_f32 v101, v101
  v_exp_f32 v102, v102
  v_exp_f32 v103, v103
  v_cvt_pk_bf16_f32 v212, v100, v101
  v_mfma_f32_32x32x16_bf16 v[180:195], v[84:87], v[196:199], v[180:195]
  v_exp_f32 v104, v104
  v_exp_f32 v105, v105
  v_cvt_pk_bf16_f32 v213, v102, v103
  v_exp_f32 v106, v106
  v_exp_f32 v107, v107
  v_cvt_pk_bf16_f32 v214, v104, v105
  v_mfma_f32_32x32x16_bf16 v[180:195], v[88:91], v[200:203], v[180:195]
  v_exp_f32 v108, v108
  v_exp_f32 v109, v109
  v_cvt_pk_bf16_f32 v215, v106, v107
  v_exp_f32 v110, v110
  v_exp_f32 v111, v111
  v_cvt_pk_bf16_f32 v216, v108, v109
  v_exp_f32 v112, v112
  v_exp_f32 v113, v113
  v_cvt_pk_bf16_f32 v217, v110, v111
  v_exp_f32 v114, v114
  v_exp_f32 v115, v115
  v_cvt_pk_bf16_f32 v218, v112, v113
  v_cvt_pk_bf16_f32 v219, v114, v115
  s_waitcnt lgkmcnt(0)
  v_mfma_f32_32x32x16_bf16 v[180:195], v[92:95], v[212:215], v[180:195]
  v_mfma_f32_32x32x16_bf16 v[180:195], v[96:99], v[216:219], v[180:195]
  s_nop 11
  s_branch L_p2_fin
L_p2_generic:
  s_sub_u32 s71, 7, s36
  s_waitcnt lgkmcnt(0)
  v_mfma_f32_32x32x16_bf16 v[116:131], v[72:75], v[12:15], 0
  v_mov_b32 v100, 0xf149f2ca
  v_mov_b32 v101, 0xf149f2ca
  v_mov_b32 v102, 0xf149f2ca
  v_mov_b32 v103, 0xf149f2ca
  v_mov_b32 v104, 0xf149f2ca
  v_mov_b32 v105, 0xf149f2ca
  v_mov_b32 v106, 0xf149f2ca
  v_mov_b32 v107, 0xf149f2ca
  v_mov_b32 v108, 0xf149f2ca
  v_mov_b32 v109, 0xf149f2ca
  v_mov_b32 v110, 0xf149f2ca
  v_mov_b32 v111, 0xf149f2ca
  v_mov_b32 v112, 0xf149f2ca
  v_mov_b32 v113, 0xf149f2ca
  v_mov_b32 v114, 0xf149f2ca
  v_mov_b32 v115, 0xf149f2ca
  v_bfi_b32 v116, v16, v100, v116
  v_bfi_b32 v117, v17, v101, v117
  v_bfi_b32 v118, v18, v102, v118
  v_bfi_b32 v119, v19, v103, v119
  v_bfi_b32 v120, v20, v104, v120
  v_bfi_b32 v121, v21, v105, v121
  v_bfi_b32 v122, v22, v106, v122
  v_bfi_b32 v123, v23, v107, v123
  v_bfi_b32 v124, v24, v108, v124
  v_bfi_b32 v125, v25, v109, v125
  v_bfi_b32 v126, v26, v110, v126
  v_bfi_b32 v127, v27, v111, v127
  v_bfi_b32 v128, v28, v112, v128
  v_bfi_b32 v129, v29, v113, v129
  v_bfi_b32 v130, v30, v114, v130
  v_bfi_b32 v131, v31, v115, v131
  v_max_f32 v7, v116, v117
  v_max3_f32 v7, v118, v119, v7
  v_max3_f32 v7, v120, v121, v7
  v_max3_f32 v7, v122, v123, v7
  v_max3_f32 v7, v124, v125, v7
  v_max3_f32 v7, v126, v127, v7
  v_max3_f32 v7, v128, v129, v7
  v_max3_f32 v7, v130, v131, v7
  s_mov_b32 s70, s71
  s_nop 1
L_p2g_p1loop:
  s_cmp_ge_u32 s70, 7
  s_cbranch_scc1 L_p2g_p1done
  s_lshl_b32 s64, s70, 10
  v_add_u32 v4, s64, v8
  ds_read_b128 v[40:43], v4 offset:1024
  s_waitcnt lgkmcnt(0)
  v_mfma_f32_32x32x16_bf16 v[100:115], v[40:43], v[12:15], 0
  s_nop 11
  v_max3_f32 v7, v100, v101, v7
  v_max3_f32 v7, v102, v103, v7
  v_max3_f32 v7, v104, v105, v7
  v_max3_f32 v7, v106, v107, v7
  v_max3_f32 v7, v108, v109, v7
  v_max3_f32 v7, v110, v111, v7
  v_max3_f32 v7, v112, v113, v7
  v_max3_f32 v7, v114, v115, v7
  s_add_u32 s70, s70, 1
  s_nop 1
  s_branch L_p2g_p1loop
L_p2g_p1done:
  v_mov_b32 v4, v7
  s_nop 1
  v_permlane32_swap_b32 v4, v7
  v_max_f32 v7, v4, v7
  v_sub_f32 v164, 0, v7
  v_sub_f32 v165, 0, v7
  v_sub_f32 v166, 0, v7
  v_sub_f32 v167, 0, v7
  v_sub_f32 v168, 0, v7
  v_sub_f32 v169, 0, v7
  v_sub_f32 v170, 0, v7
  v_sub_f32 v171, 0, v7
  v_sub_f32 v172, 0, v7
  v_sub_f32 v173, 0, v7
  v_sub_f32 v174, 0, v7
  v_sub_f32 v175, 0, v7
  v_sub_f32 v176, 0, v7
  v_sub_f32 v177, 0, v7
  v_sub_f32 v178, 0, v7
  v_sub_f32 v179, 0, v7
  s_nop 1
  v_mfma_f32_32x32x16_bf16 v[116:131], v[72:75], v[12:15], v[164:179]
  v_mov_b32 v100, 0xf149f2ca
  v_mov_b32 v101, 0xf149f2ca
  v_mov_b32 v102, 0xf149f2ca
  v_mov_b32 v103, 0xf149f2ca
  v_mov_b32 v104, 0xf149f2ca
  v_mov_b32 v105, 0xf149f2ca
  v_mov_b32 v106, 0xf149f2ca
  v_mov_b32 v107, 0xf149f2ca
  v_mov_b32 v108, 0xf149f2ca
  v_mov_b32 v109, 0xf149f2ca
  v_mov_b32 v110, 0xf149f2ca
  v_mov_b32 v111, 0xf149f2ca
  v_mov_b32 v112, 0xf149f2ca
  v_mov_b32 v113, 0xf149f2ca
  v_mov_b32 v114, 0xf149f2ca
  v_mov_b32 v115, 0xf149f2ca
  v_bfi_b32 v116, v16, v100, v116
  v_bfi_b32 v117, v17, v101, v117
  v_bfi_b32 v118, v18, v102, v118
  v_bfi_b32 v119, v19, v103, v119
  v_bfi_b32 v120, v20, v104, v120
  v_bfi_b32 v121, v21, v105, v121
  v_bfi_b32 v122, v22, v106, v122
  v_bfi_b32 v123, v23, v107, v123
  v_bfi_b32 v124, v24, v108, v124
  v_bfi_b32 v125, v25, v109, v125
  v_bfi_b32 v126, v26, v110, v126
  v_bfi_b32 v127, v27, v111, v127
  v_bfi_b32 v128, v28, v112, v128
  v_bfi_b32 v129, v29, v113, v129
  v_bfi_b32 v130, v30, v114, v130
  v_bfi_b32 v131, v31, v115, v131
  v_exp_f32 v116, v116
  v_exp_f32 v117, v117
  v_exp_f32 v118, v118
  v_exp_f32 v119, v119
  v_cvt_pk_bf16_f32 v196, v116, v117
  v_exp_f32 v120, v120
  v_exp_f32 v121, v121
  v_cvt_pk_bf16_f32 v197, v118, v119
  v_exp_f32 v122, v122
  v_exp_f32 v123, v123
  v_cvt_pk_bf16_f32 v198, v120, v121
  v_exp_f32 v124, v124
  v_exp_f32 v125, v125
  v_cvt_pk_bf16_f32 v199, v122, v123
  v_exp_f32 v126, v126
  v_exp_f32 v127, v127
  v_cvt_pk_bf16_f32 v200, v124, v125
  v_exp_f32 v128, v128
  v_exp_f32 v129, v129
  v_cvt_pk_bf16_f32 v201, v126, v127
  v_exp_f32 v130, v130
  v_exp_f32 v131, v131
  v_cvt_pk_bf16_f32 v202, v128, v129
  v_cvt_pk_bf16_f32 v203, v130, v131
  v_bfi_b32 v196, v32, 0, v196
  v_bfi_b32 v197, v33, 0, v197
  v_bfi_b32 v198, v34, 0, v198
  v_bfi_b32 v199, v35, 0, v199
  v_bfi_b32 v200, v36, 0, v200
  v_bfi_b32 v201, v37, 0, v201
  v_bfi_b32 v202, v38, 0, v202
  v_bfi_b32 v203, v39, 0, v203
  s_mov_b64 exec, s[76:77]
  ds_read_b128 v[76:79], v9 offset:8192
  ds_read_b128 v[80:83], v9 offset:8704
  s_mov_b64 exec, -1
  s_waitcnt lgkmcnt(0)
  v_mfma_f32_32x32x16_bf16 v[180:195], v[76:79], v[196:199], 0
  v_mfma_f32_32x32x16_bf16 v[180:195], v[80:83], v[200:203], v[180:195]
  s_mov_b32 s70, s71
  s_nop 10
L_p2g_p2loop:
  s_cmp_ge_u32 s70, 7
  s_cbranch_scc1 L_p2_fin
  s_lshl_b32 s64, s70, 10
  v_add_u32 v4, s64, v8
  v_add_u32 v5, s64, v9
  ds_read_b128 v[40:43], v4 offset:1024
  s_mov_b64 exec, s[76:77]
  ds_read_b128 v[76:79], v5 offset:1024
  ds_read_b128 v[80:83], v5 offset:1536
  s_mov_b64 exec, -1
  s_waitcnt lgkmcnt(0)
  v_mfma_f32_32x32x16_bf16 v[100:115], v[40:43], v[12:15], v[164:179]
  s_nop 11
  v_exp_f32 v100, v100
  v_exp_f32 v101, v101
  v_exp_f32 v102, v102
  v_exp_f32 v103, v103
  v_cvt_pk_bf16_f32 v196, v100, v101
  v_exp_f32 v104, v104
  v_exp_f32 v105, v105
  v_cvt_pk_bf16_f32 v197, v102, v103
  v_exp_f32 v106, v106
  v_exp_f32 v107, v107
  v_cvt_pk_bf16_f32 v198, v104, v105
  v_exp_f32 v108, v108
  v_exp_f32 v109, v109
  v_cvt_pk_bf16_f32 v199, v106, v107
  v_exp_f32 v110, v110
  v_exp_f32 v111, v111
  v_cvt_pk_bf16_f32 v200, v108, v109
  v_exp_f32 v112, v112
  v_exp_f32 v113, v113
  v_cvt_pk_bf16_f32 v201, v110, v111
  v_exp_f32 v114, v114
  v_exp_f32 v115, v115
  v_cvt_pk_bf16_f32 v202, v112, v113
  v_cvt_pk_bf16_f32 v203, v114, v115
  v_mfma_f32_32x32x16_bf16 v[180:195], v[76:79], v[196:199], v[180:195]
  s_nop 0
  v_mfma_f32_32x32x16_bf16 v[180:195], v[80:83], v[200:203], v[180:195]
  s_add_u32 s70, s70, 1
  s_nop 10
  s_branch L_p2g_p2loop
L_p2_fin:
  v_rcp_f32 v4, v188
  s_nop 0
  v_mul_f32 v180, v4, v180
  v_mul_f32 v181, v4, v181
  v_mul_f32 v182, v4, v182
  v_mul_f32 v183, v4, v183
  v_mul_f32 v184, v4, v184
  v_mul_f32 v185, v4, v185
  v_mul_f32 v186, v4, v186
  v_mul_f32 v187, v4, v187
  v_cvt_pk_bf16_f32 v196, v180, v181
  v_cvt_pk_bf16_f32 v197, v182, v183
  v_cvt_pk_bf16_f32 v198, v184, v185
  v_cvt_pk_bf16_f32 v199, v186, v187
  s_lshl_b32 s64, s68, 5
  s_add_u32 s64, s64, s62
  s_lshl_b32 s64, s64, 10
  s_add_u32 s64, s64, 6291456
  buffer_store_dwordx4 v[196:199], v2, s[48:51], s64 offen sc1
  s_waitcnt vmcnt(0)
  s_barrier
  s_mov_b32 s70, s63
  s_mov_b32 s71, s62
  s_cmp_lg_u32 s36, 0
  s_cbranch_scc1 L_sig1
  s_lshl_b32 s78, s70, 11
  s_add_u32 s78, s78, 20054016
  s_lshl_b32 s79, s71, 6
  s_add_u32 s78, s78, s79
  v_mov_b32 v10, s56
  v_mov_b32 v11, 0
  s_mov_b64 exec, 1
  buffer_store_dword v10, v11, s[48:51], s78 offen sc1
  s_mov_b64 exec, -1
L_sig1:
  s_and_b32 s64, s39, 7
  s_lshl_b32 s62, s37, 3
  s_add_u32 s62, s62, s64
  s_lshr_b32 s64, s39, 3
  s_lshl_b32 s63, s38, 2
  s_add_u32 s63, s63, s64
  s_mov_b32 s44, s20
  s_and_b32 s45, s21, 0xffff
  s_mov_b32 s46, 0x80000
  s_mov_b32 s47, 0x20000
  v_lshrrev_b32 v4, 3, v1
  v_and_b32 v5, 7, v1
  v_lshlrev_b32 v6, 1, v4
  v_and_b32 v6, 4, v6
  v_xor_b32 v5, v5, v6
  v_lshlrev_b32 v5, 4, v5
  s_mov_b32 s61, 1024
  v_mul_lo_u32 v3, v4, s61
  v_add_u32 v3, v3, v5
  s_mul_i32 s66, s57, 131072
  s_lshl_b32 s64, s63, 7
  s_add_u32 s66, s66, s64
  s_mul_i32 s67, s57, 16384
  s_add_u32 s67, s67, 65536
  s_mov_b32 s75, 0
  s_cmp_lt_u32 s36, 4
  s_cbranch_scc1 L_p3_nopre
  s_mov_b32 s76, s75
  s_lshl_b32 s65, s76, 14
  s_add_u32 s65, s65, s66
  s_mov_b32 m0, s67
  s_nop 0
  buffer_load_dwordx4 v3, s[44:47], s65 offen lds
  s_add_u32 s65, s65, 8192
  s_add_u32 m0, s67, 1024
  s_nop 0
  buffer_load_dwordx4 v3, s[44:47], s65 offen lds
  s_add_u32 s76, s76, 1
  s_cmp_eq_u32 s76, 8
  s_cselect_b32 s76, 0, s76
  s_lshl_b32 s65, s76, 14
  s_add_u32 s65, s65, s66
  s_add_u32 m0, s67, 2048
  s_nop 0
  buffer_load_dwordx4 v3, s[44:47], s65 offen lds
  s_add_u32 s65, s65, 8192
  s_add_u32 m0, s67, 3072
  s_nop 0
  buffer_load_dwordx4 v3, s[44:47], s65 offen lds
  s_add_u32 s76, s76, 1
  s_cmp_eq_u32 s76, 8
  s_cselect_b32 s76, 0, s76
  s_lshl_b32 s65, s76, 14
  s_add_u32 s65, s65, s66
  s_add_u32 m0, s67, 4096
  s_nop 0
  buffer_load_dwordx4 v3, s[44:47], s65 offen lds
  s_add_u32 s65, s65, 8192
  s_add_u32 m0, s67, 5120
  s_nop 0
  buffer_load_dwordx4 v3, s[44:47], s65 offen lds
  s_add_u32 s76, s76, 1
  s_cmp_eq_u32 s76, 8
  s_cselect_b32 s76, 0, s76
  s_lshl_b32 s65, s76, 14
  s_add_u32 s65, s65, s66
  s_add_u32 m0, s67, 6144
  s_nop 0
  buffer_load_dwordx4 v3, s[44:47], s65 offen lds
  s_add_u32 s65, s65, 8192
  s_add_u32 m0, s67, 7168
  s_nop 0
  buffer_load_dwordx4 v3, s[44:47], s65 offen lds
  s_add_u32 s76, s76, 1
  s_cmp_eq_u32 s76, 8
  s_cselect_b32 s76, 0, s76
  s_lshl_b32 s65, s76, 14
  s_add_u32 s65, s65, s66
  s_add_u32 m0, s67, 8192
  s_nop 0
  buffer_load_dwordx4 v3, s[44:47], s65 offen lds
  s_add_u32 s65, s65, 8192
  s_add_u32 m0, s67, 9216
  s_nop 0
  buffer_load_dwordx4 v3, s[44:47], s65 offen lds
  s_add_u32 s76, s76, 1
  s_cmp_eq_u32 s76, 8
  s_cselect_b32 s76, 0, s76
  s_lshl_b32 s65, s76, 14
  s_add_u32 s65, s65, s66
  s_add_u32 m0, s67, 10240
  s_nop 0
  buffer_load_dwordx4 v3, s[44:47], s65 offen lds
  s_add_u32 s65, s65, 8192
  s_add_u32 m0, s67, 11264
  s_nop 0
  buffer_load_dwordx4 v3, s[44:47], s65 offen lds
  s_add_u32 s76, s76, 1
  s_cmp_eq_u32 s76, 8
  s_cselect_b32 s76, 0, s76
  s_lshl_b32 s65, s76, 14
  s_add_u32 s65, s65, s66
  s_add_u32 m0, s67, 12288
  s_nop 0
  buffer_load_dwordx4 v3, s[44:47], s65 offen lds
  s_add_u32 s65, s65, 8192
  s_add_u32 m0, s67, 13312
  s_nop 0
  buffer_load_dwordx4 v3, s[44:47], s65 offen lds
  s_add_u32 s76, s76, 1
  s_cmp_eq_u32 s76, 8
  s_cselect_b32 s76, 0, s76
  s_lshl_b32 s65, s76, 14
  s_add_u32 s65, s65, s66
  s_add_u32 m0, s67, 14336
  s_nop 0
  buffer_load_dwordx4 v3, s[44:47], s65 offen lds
  s_add_u32 s65, s65, 8192
  s_add_u32 m0, s67, 15360
  s_nop 0
  buffer_load_dwordx4 v3, s[44:47], s65 offen lds
  s_add_u32 s76, s76, 1
  s_cmp_eq_u32 s76, 8
  s_cselect_b32 s76, 0, s76
L_p3_nopre:
  s_and_b32 s64, s39, 7
  s_lshl_b32 s62, s37, 3
  s_add_u32 s62, s62, s64
  s_lshr_b32 s64, s39, 3
  s_lshl_b32 s63, s38, 2
  s_add_u32 s63, s63, s64
  s_cmp_lt_u32 s36, 4
  s_cbranch_scc0 L_p3_helper
  s_and_b32 s66, s36, 1
  s_lshr_b32 s67, s36, 1
  s_lshl_b32 s64, s62, 1
  s_add_u32 s64, s64, s66
  s_mov_b32 s70, s64
  s_mul_i32 s68, s64, 32768
  s_mul_i32 s64, s67, 16384
  s_add_u32 s68, s68, s64
  s_add_u32 s68, s68, 6291456
  s_lshl_b32 s69, s70, 5
  s_lshl_b32 s64, s63, 2
  s_add_u32 s69, s69, s64
  s_lshl_b32 s64, s67, 1
  s_add_u32 s69, s69, s64
  s_lshl_b32 s69, s69, 10
  s_add_u32 s69, s69, 8388608
  s_xor_b32 s64, s67, 0
  v_and_b32 v4, 15, v1
  v_lshrrev_b32 v5, 2, v4
  v_lshrrev_b32 v6, 5, v1
  v_lshlrev_b32 v6, 2, v6
  v_add_u32 v5, v5, v6
  v_lshlrev_b32 v8, 7, v5
  v_lshrrev_b32 v5, 3, v4
  v_xor_b32 v5, s64, v5
  v_lshlrev_b32 v5, 6, v5
  v_add_u32 v8, v8, v5
  v_and_b32 v5, 16, v1
  v_lshlrev_b32 v5, 1, v5
  v_add_u32 v8, v8, v5
  v_and_b32 v5, 3, v4
  v_lshlrev_b32 v5, 3, v5
  v_add_u32 v8, v8, v5
  s_lshl_b32 s65, s67, 15
  s_add_u32 s65, s65, 65536
  v_add_u32 v8, s65, v8
  s_xor_b32 s64, s67, 1
  v_and_b32 v4, 15, v1
  v_lshrrev_b32 v5, 2, v4
  v_lshrrev_b32 v6, 5, v1
  v_lshlrev_b32 v6, 2, v6
  v_add_u32 v5, v5, v6
  v_lshlrev_b32 v9, 7, v5
  v_lshrrev_b32 v5, 3, v4
  v_xor_b32 v5, s64, v5
  v_lshlrev_b32 v5, 6, v5
  v_add_u32 v9, v9, v5
  v_and_b32 v5, 16, v1
  v_lshlrev_b32 v5, 1, v5
  v_add_u32 v9, v9, v5
  v_and_b32 v5, 3, v4
  v_lshlrev_b32 v5, 3, v5
  v_add_u32 v9, v9, v5
  s_lshl_b32 s65, s67, 15
  s_add_u32 s65, s65, 65536
  v_add_u32 v9, s65, v9
  v_and_b32 v4, 31, v1
  v_lshlrev_b32 v14, 10, v4
  v_lshrrev_b32 v4, 5, v1
  v_lshlrev_b32 v4, 3, v4
  v_add_u32 v14, v14, v4
  s_lshl_b32 s71, s70, 15
  s_lshl_b32 s64, s63, 7
  s_add_u32 s71, s71, s64
  s_lshl_b32 s64, s67, 6
  s_add_u32 s71, s71, s64
  s_lshl_b32 s64, s36, 12
  v_add_u32 v15, s64, v2
  s_xor_b32 s64, s36, 2
  s_lshl_b32 s64, s64, 12
  v_add_u32 v7, s64, v2
  s_mov_b32 s40, s16
  s_and_b32 s41, s17, 0xffff
  s_mov_b32 s42, 0x200000
  s_mov_b32 s43, 0x20000
  buffer_load_dwordx2 v[240:241], v14, s[40:43], s71 offen offset:0
  buffer_load_dwordx2 v[242:243], v14, s[40:43], s71 offen offset:16
  buffer_load_dwordx2 v[244:245], v14, s[40:43], s71 offen offset:32
  buffer_load_dwordx2 v[246:247], v14, s[40:43], s71 offen offset:48
  s_lshr_b32 s72, s62, 2
  s_lshl_b32 s78, s72, 11
  s_add_u32 s78, s78, 20054016
  v_lshlrev_b32 v250, 6, v1
  s_mov_b32 exec_lo, 0xffffffff
  s_mov_b32 exec_hi, 0
  s_mov_b32 s79, 0
  s_waitcnt vmcnt(0)
  buffer_load_dword v251, v250, s[48:51], s78 offen sc1
  s_sleep 3
  buffer_load_dword v252, v250, s[48:51], s78 offen sc1
L_wfp3_poll:
  s_waitcnt vmcnt(1)
  v_cmp_ne_u32 vcc, s56, v251
  s_cbranch_vccz L_wfp3_out
  buffer_load_dword v251, v250, s[48:51], s78 offen sc1
  s_waitcnt vmcnt(1)
  v_cmp_ne_u32 vcc, s56, v252
  s_cbranch_vccz L_wfp3_out
  buffer_load_dword v252, v250, s[48:51], s78 offen sc1
  s_add_u32 s79, s79, 1
  s_cmp_gt_u32 s79, 0x40000
  s_cbranch_scc0 L_wfp3_poll
L_wfp3_out:
  s_mov_b64 exec, -1
  s_add_u32 s73, s68, 0
  buffer_load_dwordx4 v[64:67], v2, s[48:51], s73 offen offset:0 sc1
  buffer_load_dwordx4 v[68:71], v2, s[48:51], s73 offen offset:1024 sc1
  buffer_load_dwordx4 v[72:75], v2, s[48:51], s73 offen offset:2048 sc1
  buffer_load_dwordx4 v[76:79], v2, s[48:51], s73 offen offset:3072 sc1
  s_add_u32 s73, s68, 4096
  buffer_load_dwordx4 v[80:83], v2, s[48:51], s73 offen offset:0 sc1
  buffer_load_dwordx4 v[84:87], v2, s[48:51], s73 offen offset:1024 sc1
  buffer_load_dwordx4 v[88:91], v2, s[48:51], s73 offen offset:2048 sc1
  buffer_load_dwordx4 v[92:95], v2, s[48:51], s73 offen offset:3072 sc1
  s_barrier
  ds_read_b64_tr_b16 v[48:49], v8 offset:0
  ds_read_b64_tr_b16 v[50:51], v8 offset:1024
  ds_read_b64_tr_b16 v[52:53], v9 offset:0
  ds_read_b64_tr_b16 v[54:55], v9 offset:1024
  s_waitcnt vmcnt(7)
  s_waitcnt lgkmcnt(2)
  v_mfma_f32_32x32x16_bf16 v[16:31], v[48:51], v[64:67], 0
  ds_read_b64_tr_b16 v[56:57], v8 offset:2048
  ds_read_b64_tr_b16 v[58:59], v8 offset:3072
  s_add_u32 s73, s68, 8192
  buffer_load_dwordx4 v[96:99], v2, s[48:51], s73 offen offset:0 sc1
  s_waitcnt lgkmcnt(2)
  v_mfma_f32_32x32x16_bf16 v[32:47], v[52:55], v[64:67], 0
  ds_read_b64_tr_b16 v[60:61], v9 offset:2048
  ds_read_b64_tr_b16 v[62:63], v9 offset:3072
  s_waitcnt vmcnt(7)
  s_waitcnt lgkmcnt(2)
  v_mfma_f32_32x32x16_bf16 v[16:31], v[56:59], v[68:71], v[16:31]
  ds_read_b64_tr_b16 v[48:49], v8 offset:4096
  ds_read_b64_tr_b16 v[50:51], v8 offset:5120
  buffer_load_dwordx4 v[100:103], v2, s[48:51], s73 offen offset:1024 sc1
  s_waitcnt lgkmcnt(2)
  v_mfma_f32_32x32x16_bf16 v[32:47], v[60:63], v[68:71], v[32:47]
  ds_read_b64_tr_b16 v[52:53], v9 offset:4096
  ds_read_b64_tr_b16 v[54:55], v9 offset:5120
  s_waitcnt vmcnt(7)
  s_waitcnt lgkmcnt(2)
  v_mfma_f32_32x32x16_bf16 v[16:31], v[48:51], v[72:75], v[16:31]
  ds_read_b64_tr_b16 v[56:57], v8 offset:6144
  ds_read_b64_tr_b16 v[58:59], v8 offset:7168
  buffer_load_dwordx4 v[104:107], v2, s[48:51], s73 offen offset:2048 sc1
  s_waitcnt lgkmcnt(2)
  v_mfma_f32_32x32x16_bf16 v[32:47], v[52:55], v[72:75], v[32:47]
  ds_read_b64_tr_b16 v[60:61], v9 offset:6144
  ds_read_b64_tr_b16 v[62:63], v9 offset:7168
  s_waitcnt vmcnt(7)
  s_waitcnt lgkmcnt(2)
  v_mfma_f32_32x32x16_bf16 v[16:31], v[56:59], v[76:79], v[16:31]
  ds_read_b64_tr_b16 v[48:49], v8 offset:8192
  ds_read_b64_tr_b16 v[50:51], v8 offset:9216
  buffer_load_dwordx4 v[108:111], v2, s[48:51], s73 offen offset:3072 sc1
  s_waitcnt lgkmcnt(2)
  v_mfma_f32_32x32x16_bf16 v[32:47], v[60:63], v[76:79], v[32:47]
  ds_read_b64_tr_b16 v[52:53], v9 offset:8192
  ds_read_b64_tr_b16 v[54:55], v9 offset:9216
  s_waitcnt vmcnt(7)
  s_waitcnt lgkmcnt(2)
  v_mfma_f32_32x32x16_bf16 v[16:31], v[48:51], v[80:83], v[16:31]
  ds_read_b64_tr_b16 v[56:57], v8 offset:10240
  ds_read_b64_tr_b16 v[58:59], v8 offset:11264
  s_add_u32 s73, s68, 12288
  buffer_load_dwordx4 v[112:115], v2, s[48:51], s73 offen offset:0 sc1
  s_waitcnt lgkmcnt(2)
  v_mfma_f32_32x32x16_bf16 v[32:47], v[52:55], v[80:83], v[32:47]
  ds_read_b64_tr_b16 v[60:61], v9 offset:10240
  ds_read_b64_tr_b16 v[62:63], v9 offset:11264
  s_waitcnt vmcnt(7)
  s_waitcnt lgkmcnt(2)
  v_mfma_f32_32x32x16_bf16 v[16:31], v[56:59], v[84:87], v[16:31]
  ds_read_b64_tr_b16 v[48:49], v8 offset:12288
  ds_read_b64_tr_b16 v[50:51], v8 offset:13312
  buffer_load_dwordx4 v[116:119], v2, s[48:51], s73 offen offset:1024 sc1
  s_waitcnt lgkmcnt(2)
  v_mfma_f32_32x32x16_bf16 v[32:47], v[60:63], v[84:87], v[32:47]
  ds_read_b64_tr_b16 v[52:53], v9 offset:12288
  ds_read_b64_tr_b16 v[54:55], v9 offset:13312
  s_waitcnt vmcnt(7)
  s_waitcnt lgkmcnt(2)
  v_mfma_f32_32x32x16_bf16 v[16:31], v[48:51], v[88:91], v[16:31]
  ds_read_b64_tr_b16 v[56:57], v8 offset:14336
  ds_read_b64_tr_b16 v[58:59], v8 offset:15360
  buffer_load_dwordx4 v[120:123], v2, s[48:51], s73 offen offset:2048 sc1
  s_waitcnt lgkmcnt(2)
  v_mfma_f32_32x32x16_bf16 v[32:47], v[52:55], v[88:91], v[32:47]
  ds_read_b64_tr_b16 v[60:61], v9 offset:14336
  ds_read_b64_tr_b16 v[62:63], v9 offset:15360
  s_waitcnt vmcnt(7)
  s_waitcnt lgkmcnt(2)
  v_mfma_f32_32x32x16_bf16 v[16:31], v[56:59], v[92:95], v[16:31]
  ds_read_b64_tr_b16 v[48:49], v8 offset:16384
  ds_read_b64_tr_b16 v[50:51], v8 offset:17408
  buffer_load_dwordx4 v[124:127], v2, s[48:51], s73 offen offset:3072 sc1
  s_waitcnt lgkmcnt(2)
  v_mfma_f32_32x32x16_bf16 v[32:47], v[60:63], v[92:95], v[32:47]
  ds_read_b64_tr_b16 v[52:53], v9 offset:16384
  ds_read_b64_tr_b16 v[54:55], v9 offset:17408
  s_waitcnt vmcnt(7)
  s_waitcnt lgkmcnt(2)
  v_mfma_f32_32x32x16_bf16 v[16:31], v[48:51], v[96:99], v[16:31]
  ds_read_b64_tr_b16 v[56:57], v8 offset:18432
  ds_read_b64_tr_b16 v[58:59], v8 offset:19456
  s_waitcnt lgkmcnt(2)
  v_mfma_f32_32x32x16_bf16 v[32:47], v[52:55], v[96:99], v[32:47]
  ds_read_b64_tr_b16 v[60:61], v9 offset:18432
  ds_read_b64_tr_b16 v[62:63], v9 offset:19456
  s_waitcnt vmcnt(6)
  s_waitcnt lgkmcnt(2)
  v_mfma_f32_32x32x16_bf16 v[16:31], v[56:59], v[100:103], v[16:31]
  ds_read_b64_tr_b16 v[48:49], v8 offset:20480
  ds_read_b64_tr_b16 v[50:51], v8 offset:21504
  s_waitcnt lgkmcnt(2)
  v_mfma_f32_32x32x16_bf16 v[32:47], v[60:63], v[100:103], v[32:47]
  ds_read_b64_tr_b16 v[52:53], v9 offset:20480
  ds_read_b64_tr_b16 v[54:55], v9 offset:21504
  s_waitcnt vmcnt(5)
  s_waitcnt lgkmcnt(2)
  v_mfma_f32_32x32x16_bf16 v[16:31], v[48:51], v[104:107], v[16:31]
  ds_read_b64_tr_b16 v[56:57], v8 offset:22528
  ds_read_b64_tr_b16 v[58:59], v8 offset:23552
  s_waitcnt lgkmcnt(2)
  v_mfma_f32_32x32x16_bf16 v[32:47], v[52:55], v[104:107], v[32:47]
  ds_read_b64_tr_b16 v[60:61], v9 offset:22528
  ds_read_b64_tr_b16 v[62:63], v9 offset:23552
  s_waitcnt vmcnt(4)
  s_waitcnt lgkmcnt(2)
  v_mfma_f32_32x32x16_bf16 v[16:31], v[56:59], v[108:111], v[16:31]
  ds_read_b64_tr_b16 v[48:49], v8 offset:24576
  ds_read_b64_tr_b16 v[50:51], v8 offset:25600
  s_waitcnt lgkmcnt(2)
  v_mfma_f32_32x32x16_bf16 v[32:47], v[60:63], v[108:111], v[32:47]
  ds_read_b64_tr_b16 v[52:53], v9 offset:24576
  ds_read_b64_tr_b16 v[54:55], v9 offset:25600
  s_waitcnt vmcnt(3)
  s_waitcnt lgkmcnt(2)
  v_mfma_f32_32x32x16_bf16 v[16:31], v[48:51], v[112:115], v[16:31]
  ds_read_b64_tr_b16 v[56:57], v8 offset:26624
  ds_read_b64_tr_b16 v[58:59], v8 offset:27648
  s_waitcnt lgkmcnt(2)
  v_mfma_f32_32x32x16_bf16 v[32:47], v[52:55], v[112:115], v[32:47]
  ds_read_b64_tr_b16 v[60:61], v9 offset:26624
  ds_read_b64_tr_b16 v[62:63], v9 offset:27648
  s_waitcnt vmcnt(2)
  s_waitcnt lgkmcnt(2)
  v_mfma_f32_32x32x16_bf16 v[16:31], v[56:59], v[116:119], v[16:31]
  ds_read_b64_tr_b16 v[48:49], v8 offset:28672
  ds_read_b64_tr_b16 v[50:51], v8 offset:29696
  s_waitcnt lgkmcnt(2)
  v_mfma_f32_32x32x16_bf16 v[32:47], v[60:63], v[116:119], v[32:47]
  ds_read_b64_tr_b16 v[52:53], v9 offset:28672
  ds_read_b64_tr_b16 v[54:55], v9 offset:29696
  s_waitcnt vmcnt(1)
  s_waitcnt lgkmcnt(2)
  v_mfma_f32_32x32x16_bf16 v[16:31], v[48:51], v[120:123], v[16:31]
  ds_read_b64_tr_b16 v[56:57], v8 offset:30720
  ds_read_b64_tr_b16 v[58:59], v8 offset:31744
  s_waitcnt lgkmcnt(2)
  v_mfma_f32_32x32x16_bf16 v[32:47], v[52:55], v[120:123], v[32:47]
  ds_read_b64_tr_b16 v[60:61], v9 offset:30720
  ds_read_b64_tr_b16 v[62:63], v9 offset:31744
  s_waitcnt vmcnt(0)
  s_waitcnt lgkmcnt(2)
  v_mfma_f32_32x32x16_bf16 v[16:31], v[56:59], v[124:127], v[16:31]
  s_waitcnt lgkmcnt(0)
  v_mfma_f32_32x32x16_bf16 v[32:47], v[60:63], v[124:127], v[32:47]
  s_nop 11
  ds_write_b128 v15, v[32:35] offset:0
  ds_write_b128 v15, v[36:39] offset:1024
  ds_write_b128 v15, v[40:43] offset:2048
  ds_write_b128 v15, v[44:47] offset:3072
  s_waitcnt lgkmcnt(0)
  s_barrier
  ds_read_b128 v[32:35], v7 offset:0
  ds_read_b128 v[36:39], v7 offset:1024
  ds_read_b128 v[40:43], v7 offset:2048
  ds_read_b128 v[44:47], v7 offset:3072
  s_waitcnt vmcnt(0)
  v_lshlrev_b32 v64, 16, v240
  v_and_b32 v65, 0xffff0000, v240
  v_lshlrev_b32 v66, 16, v241
  v_and_b32 v67, 0xffff0000, v241
  v_lshlrev_b32 v68, 16, v242
  v_and_b32 v69, 0xffff0000, v242
  v_lshlrev_b32 v70, 16, v243
  v_and_b32 v71, 0xffff0000, v243
  v_lshlrev_b32 v72, 16, v244
  v_and_b32 v73, 0xffff0000, v244
  v_lshlrev_b32 v74, 16, v245
  v_and_b32 v75, 0xffff0000, v245
  v_lshlrev_b32 v76, 16, v246
  v_and_b32 v77, 0xffff0000, v246
  v_lshlrev_b32 v78, 16, v247
  v_and_b32 v79, 0xffff0000, v247
  v_add_f32 v16, v16, v64
  v_add_f32 v17, v17, v65
  v_add_f32 v18, v18, v66
  v_add_f32 v19, v19, v67
  v_add_f32 v20, v20, v68
  v_add_f32 v21, v21, v69
  v_add_f32 v22, v22, v70
  v_add_f32 v23, v23, v71
  v_add_f32 v24, v24, v72
  v_add_f32 v25, v25, v73
  v_add_f32 v26, v26, v74
  v_add_f32 v27, v27, v75
  v_add_f32 v28, v28, v76
  v_add_f32 v29, v29, v77
  v_add_f32 v30, v30, v78
  v_add_f32 v31, v31, v79
  s_waitcnt lgkmcnt(0)
  s_barrier
  v_add_f32 v16, v16, v32
  v_add_f32 v17, v17, v33
  v_add_f32 v18, v18, v34
  v_add_f32 v19, v19, v35
  v_add_f32 v20, v20, v36
  v_add_f32 v21, v21, v37
  v_add_f32 v22, v22, v38
  v_add_f32 v23, v23, v39
  v_add_f32 v24, v24, v40
  v_add_f32 v25, v25, v41
  v_add_f32 v26, v26, v42
  v_add_f32 v27, v27, v43
  v_add_f32 v28, v28, v44
  v_add_f32 v29, v29, v45
  v_add_f32 v30, v30, v46
  v_add_f32 v31, v31, v47
  v_cvt_pk_bf16_f32 v80, v16, v17
  v_cvt_pk_bf16_f32 v81, v18, v19
  v_cvt_pk_bf16_f32 v82, v20, v21
  v_cvt_pk_bf16_f32 v83, v22, v23
  v_cvt_pk_bf16_f32 v84, v24, v25
  v_cvt_pk_bf16_f32 v85, v26, v27
  v_cvt_pk_bf16_f32 v86, v28, v29
  v_cvt_pk_bf16_f32 v87, v30, v31
  buffer_store_dwordx4 v[80:83], v2, s[48:51], s69 offen offset:0 sc1
  buffer_store_dwordx4 v[84:87], v2, s[48:51], s69 offen offset:1024 sc1
  v_mov_b32 v88, 0
  v_mov_b32 v89, 0
  v_mov_b32 v90, 0x3f803f80
  v_dot2_f32_bf16 v88, v80, v90, v88
  v_dot2_f32_bf16 v89, v80, v80, v89
  v_dot2_f32_bf16 v88, v81, v90, v88
  v_dot2_f32_bf16 v89, v81, v81, v89
  v_dot2_f32_bf16 v88, v82, v90, v88
  v_dot2_f32_bf16 v89, v82, v82, v89
  v_dot2_f32_bf16 v88, v83, v90, v88
  v_dot2_f32_bf16 v89, v83, v83, v89
  v_dot2_f32_bf16 v88, v84, v90, v88
  v_dot2_f32_bf16 v89, v84, v84, v89
  v_dot2_f32_bf16 v88, v85, v90, v88
  v_dot2_f32_bf16 v89, v85, v85, v89
  v_dot2_f32_bf16 v88, v86, v90, v88
  v_dot2_f32_bf16 v89, v86, v86, v89
  v_dot2_f32_bf16 v88, v87, v90, v88
  v_dot2_f32_bf16 v89, v87, v87, v89
  s_nop 1
  v_mov_b32 v92, v88
  v_mov_b32 v93, v89
  s_nop 0
  v_permlane32_swap_b32 v92, v88
  v_permlane32_swap_b32 v93, v89
  v_add_f32 v88, v88, v92
  v_add_f32 v89, v89, v93
  v_and_b32 v4, 31, v1
  v_lshlrev_b32 v4, 4, v4
  s_lshl_b32 s64, s63, 15
  s_lshl_b32 s72, s70, 9
  s_add_u32 s64, s64, s72
  s_lshl_b32 s72, s67, 3
  s_add_u32 s64, s64, s72
  s_add_u32 s64, s64, 10485760
  s_mov_b32 exec_hi, 0
  buffer_store_dwordx2 v[88:89], v4, s[48:51], s64 offen sc1
  s_mov_b64 exec, -1
  s_branch L_p3_done
L_p3_helper:
  s_waitcnt vmcnt(0)
  s_barrier
  s_barrier
  s_barrier
L_p3_done:
  s_waitcnt vmcnt(0)
  s_barrier
  s_lshr_b32 s70, s62, 1
  s_and_b32 s71, s62, 1
  s_lshl_b32 s71, s71, 3
  s_add_u32 s71, s71, s63
  s_cmp_lg_u32 s36, 0
  s_cbranch_scc1 L_sig2
  s_lshl_b32 s78, s70, 11
  s_add_u32 s78, s78, 20185088
  s_lshl_b32 s79, s71, 6
  s_add_u32 s78, s78, s79
  v_mov_b32 v10, s56
  v_mov_b32 v11, 0
  s_mov_b64 exec, 1
  buffer_store_dword v10, v11, s[48:51], s78 offen sc1
  s_mov_b64 exec, -1
L_sig2:
  s_and_b32 s64, s39, 3
  s_lshl_b32 s62, s37, 2
  s_add_u32 s62, s62, s64
  s_lshr_b32 s64, s39, 2
  s_mul_i32 s63, s38, 7
  s_add_u32 s63, s63, s64
  s_cmp_eq_u32 s64, 7
  s_and_b32 s75, s64, 7
  s_mov_b32 s77, s64
  s_cmp_lt_u32 s36, 4
  s_cselect_b32 s40, s24, s26
  s_cselect_b32 s41, s25, s27
  s_and_b32 s41, s41, 0xffff
  s_mov_b32 s42, 0x1c0000
  s_mov_b32 s43, 0x20000
  v_lshrrev_b32 v5, 3, v1
  v_and_b32 v6, 7, v1
  v_and_b32 v7, 2, v5
  v_xor_b32 v6, v6, v7
  s_and_b32 s65, s36, 4
  v_xor_b32 v6, s65, v6
  s_mov_b32 s65, 3584
  v_mul_lo_u32 v5, v5, s65
  v_lshlrev_b32 v6, 4, v6
  v_add_u32 v3, v5, v6
  s_lshl_b32 s66, s63, 8
  s_lshr_b32 s65, s36, 1
  s_and_b32 s65, s65, 1
  s_mul_i32 s65, s65, 917504
  s_add_u32 s66, s66, s65
  s_and_b32 s65, s36, 1
  s_mul_i32 s65, s65, 57344
  s_add_u32 s66, s66, s65
  s_lshr_b32 s67, s36, 2
  s_lshl_b32 s67, s67, 13
  s_and_b32 s65, s36, 3
  s_lshl_b32 s65, s65, 11
  s_add_u32 s67, s67, s65
  s_cmp_eq_u32 s77, 7
  s_cbranch_scc1 L_p4_nopre
  s_cmp_eq_u32 s36, 0
  s_cbranch_scc1 L_p4_nopre
  s_cmp_eq_u32 s36, 1
  s_cbranch_scc1 L_p4_pre1
  s_add_u32 s76, s75, 0
  s_and_b32 s76, s76, 7
  s_mul_i32 s76, s76, 114688
  s_add_u32 s76, s76, s66
  s_mov_b32 m0, s67
  s_nop 0
  buffer_load_dwordx4 v3, s[40:43], s76 offen lds
  s_add_u32 s76, s76, 28672
  s_add_u32 m0, s67, 1024
  s_nop 0
  buffer_load_dwordx4 v3, s[40:43], s76 offen lds
  s_add_u32 s76, s75, 1
  s_and_b32 s76, s76, 7
  s_mul_i32 s76, s76, 114688
  s_add_u32 s76, s76, s66
  s_add_u32 m0, s67, 16384
  s_nop 0
  buffer_load_dwordx4 v3, s[40:43], s76 offen lds
  s_add_u32 s76, s76, 28672
  s_add_u32 m0, s67, 17408
  s_nop 0
  buffer_load_dwordx4 v3, s[40:43], s76 offen lds
  s_add_u32 s76, s75, 2
  s_and_b32 s76, s76, 7
  s_mul_i32 s76, s76, 114688
  s_add_u32 s76, s76, s66
  s_add_u32 m0, s67, 32768
  s_nop 0
  buffer_load_dwordx4 v3, s[40:43], s76 offen lds
  s_add_u32 s76, s76, 28672
  s_add_u32 m0, s67, 33792
  s_nop 0
  buffer_load_dwordx4 v3, s[40:43], s76 offen lds
  s_add_u32 s76, s75, 3
  s_and_b32 s76, s76, 7
  s_mul_i32 s76, s76, 114688
  s_add_u32 s76, s76, s66
  s_add_u32 m0, s67, 49152
  s_nop 0
  buffer_load_dwordx4 v3, s[40:43], s76 offen lds
  s_add_u32 s76, s76, 28672
  s_add_u32 m0, s67, 50176
  s_nop 0
  buffer_load_dwordx4 v3, s[40:43], s76 offen lds
  s_add_u32 s76, s75, 4
  s_and_b32 s76, s76, 7
  s_mul_i32 s76, s76, 114688
  s_add_u32 s76, s76, s66
  s_add_u32 m0, s67, 65536
  s_nop 0
  buffer_load_dwordx4 v3, s[40:43], s76 offen lds
  s_add_u32 s76, s76, 28672
  s_add_u32 m0, s67, 66560
  s_nop 0
  buffer_load_dwordx4 v3, s[40:43], s76 offen lds
  s_add_u32 s76, s75, 5
  s_and_b32 s76, s76, 7
  s_mul_i32 s76, s76, 114688
  s_add_u32 s76, s76, s66
  s_add_u32 m0, s67, 81920
  s_nop 0
  buffer_load_dwordx4 v3, s[40:43], s76 offen lds
  s_add_u32 s76, s76, 28672
  s_add_u32 m0, s67, 82944
  s_nop 0
  buffer_load_dwordx4 v3, s[40:43], s76 offen lds
  s_add_u32 s76, s75, 6
  s_and_b32 s76, s76, 7
  s_mul_i32 s76, s76, 114688
  s_add_u32 s76, s76, s66
  s_add_u32 m0, s67, 98304
  s_nop 0
  buffer_load_dwordx4 v3, s[40:43], s76 offen lds
  s_add_u32 s76, s76, 28672
  s_add_u32 m0, s67, 99328
  s_nop 0
  buffer_load_dwordx4 v3, s[40:43], s76 offen lds
  s_add_u32 s76, s75, 7
  s_and_b32 s76, s76, 7
  s_mul_i32 s76, s76, 114688
  s_add_u32 s76, s76, s66
  s_add_u32 m0, s67, 114688
  s_nop 0
  buffer_load_dwordx4 v3, s[40:43], s76 offen lds
  s_add_u32 s76, s76, 28672
  s_add_u32 m0, s67, 115712
  s_nop 0
  buffer_load_dwordx4 v3, s[40:43], s76 offen lds
  s_branch L_p4_nopre
L_p4_pre1:
  s_add_u32 s76, s75, 0
  s_and_b32 s76, s76, 7
  s_mul_i32 s76, s76, 114688
  s_add_u32 s76, s76, s66
  s_mov_b32 m0, s67
  s_nop 0
  buffer_load_dwordx4 v3, s[40:43], s76 offen lds
  s_add_u32 s76, s76, 28672
  s_add_u32 m0, s67, 1024
  s_nop 0
  buffer_load_dwordx4 v3, s[40:43], s76 offen lds
  s_sub_u32 s76, s76, 86016
  s_add_u32 m0, s67, 4294965248
  s_nop 0
  buffer_load_dwordx4 v3, s[40:43], s76 offen lds
  s_add_u32 s76, s76, 28672
  s_add_u32 m0, s67, 4294966272
  s_nop 0
  buffer_load_dwordx4 v3, s[40:43], s76 offen lds
  s_add_u32 s76, s75, 1
  s_and_b32 s76, s76, 7
  s_mul_i32 s76, s76, 114688
  s_add_u32 s76, s76, s66
  s_add_u32 m0, s67, 16384
  s_nop 0
  buffer_load_dwordx4 v3, s[40:43], s76 offen lds
  s_add_u32 s76, s76, 28672
  s_add_u32 m0, s67, 17408
  s_nop 0
  buffer_load_dwordx4 v3, s[40:43], s76 offen lds
  s_sub_u32 s76, s76, 86016
  s_add_u32 m0, s67, 14336
  s_nop 0
  buffer_load_dwordx4 v3, s[40:43], s76 offen lds
  s_add_u32 s76, s76, 28672
  s_add_u32 m0, s67, 15360
  s_nop 0
  buffer_load_dwordx4 v3, s[40:43], s76 offen lds
  s_add_u32 s76, s75, 2
  s_and_b32 s76, s76, 7
  s_mul_i32 s76, s76, 114688
  s_add_u32 s76, s76, s66
  s_add_u32 m0, s67, 32768
  s_nop 0
  buffer_load_dwordx4 v3, s[40:43], s76 offen lds
  s_add_u32 s76, s76, 28672
  s_add_u32 m0, s67, 33792
  s_nop 0
  buffer_load_dwordx4 v3, s[40:43], s76 offen lds
  s_sub_u32 s76, s76, 86016
  s_add_u32 m0, s67, 30720
  s_nop 0
  buffer_load_dwordx4 v3, s[40:43], s76 offen lds
  s_add_u32 s76, s76, 28672
  s_add_u32 m0, s67, 31744
  s_nop 0
  buffer_load_dwordx4 v3, s[40:43], s76 offen lds
  s_add_u32 s76, s75, 3
  s_and_b32 s76, s76, 7
  s_mul_i32 s76, s76, 114688
  s_add_u32 s76, s76, s66
  s_add_u32 m0, s67, 49152
  s_nop 0
  buffer_load_dwordx4 v3, s[40:43], s76 offen lds
  s_add_u32 s76, s76, 28672
  s_add_u32 m0, s67, 50176
  s_nop 0
  buffer_load_dwordx4 v3, s[40:43], s76 offen lds
  s_sub_u32 s76, s76, 86016
  s_add_u32 m0, s67, 47104
  s_nop 0
  buffer_load_dwordx4 v3, s[40:43], s76 offen lds
  s_add_u32 s76, s76, 28672
  s_add_u32 m0, s67, 48128
  s_nop 0
  buffer_load_dwordx4 v3, s[40:43], s76 offen lds
  s_add_u32 s76, s75, 4
  s_and_b32 s76, s76, 7
  s_mul_i32 s76, s76, 114688
  s_add_u32 s76, s76, s66
  s_add_u32 m0, s67, 65536
  s_nop 0
  buffer_load_dwordx4 v3, s[40:43], s76 offen lds
  s_add_u32 s76, s76, 28672
  s_add_u32 m0, s67, 66560
  s_nop 0
  buffer_load_dwordx4 v3, s[40:43], s76 offen lds
  s_sub_u32 s76, s76, 86016
  s_add_u32 m0, s67, 63488
  s_nop 0
  buffer_load_dwordx4 v3, s[40:43], s76 offen lds
  s_add_u32 s76, s76, 28672
  s_add_u32 m0, s67, 64512
  s_nop 0
  buffer_load_dwordx4 v3, s[40:43], s76 offen lds
  s_add_u32 s76, s75, 5
  s_and_b32 s76, s76, 7
  s_mul_i32 s76, s76, 114688
  s_add_u32 s76, s76, s66
  s_add_u32 m0, s67, 81920
  s_nop 0
  buffer_load_dwordx4 v3, s[40:43], s76 offen lds
  s_add_u32 s76, s76, 28672
  s_add_u32 m0, s67, 82944
  s_nop 0
  buffer_load_dwordx4 v3, s[40:43], s76 offen lds
  s_sub_u32 s76, s76, 86016
  s_add_u32 m0, s67, 79872
  s_nop 0
  buffer_load_dwordx4 v3, s[40:43], s76 offen lds
  s_add_u32 s76, s76, 28672
  s_add_u32 m0, s67, 80896
  s_nop 0
  buffer_load_dwordx4 v3, s[40:43], s76 offen lds
  s_add_u32 s76, s75, 6
  s_and_b32 s76, s76, 7
  s_mul_i32 s76, s76, 114688
  s_add_u32 s76, s76, s66
  s_add_u32 m0, s67, 98304
  s_nop 0
  buffer_load_dwordx4 v3, s[40:43], s76 offen lds
  s_add_u32 s76, s76, 28672
  s_add_u32 m0, s67, 99328
  s_nop 0
  buffer_load_dwordx4 v3, s[40:43], s76 offen lds
  s_sub_u32 s76, s76, 86016
  s_add_u32 m0, s67, 96256
  s_nop 0
  buffer_load_dwordx4 v3, s[40:43], s76 offen lds
  s_add_u32 s76, s76, 28672
  s_add_u32 m0, s67, 97280
  s_nop 0
  buffer_load_dwordx4 v3, s[40:43], s76 offen lds
  s_add_u32 s76, s75, 7
  s_and_b32 s76, s76, 7
  s_mul_i32 s76, s76, 114688
  s_add_u32 s76, s76, s66
  s_add_u32 m0, s67, 114688
  s_nop 0
  buffer_load_dwordx4 v3, s[40:43], s76 offen lds
  s_add_u32 s76, s76, 28672
  s_add_u32 m0, s67, 115712
  s_nop 0
  buffer_load_dwordx4 v3, s[40:43], s76 offen lds
  s_sub_u32 s76, s76, 86016
  s_add_u32 m0, s67, 112640
  s_nop 0
  buffer_load_dwordx4 v3, s[40:43], s76 offen lds
  s_add_u32 s76, s76, 28672
  s_add_u32 m0, s67, 113664
  s_nop 0
  buffer_load_dwordx4 v3, s[40:43], s76 offen lds
L_p4_nopre:
  s_and_b32 s64, s39, 3
  s_lshl_b32 s62, s37, 2
  s_add_u32 s62, s62, s64
  s_lshr_b32 s64, s39, 2
  s_mul_i32 s63, s38, 7
  s_add_u32 s63, s63, s64
  s_cmp_eq_u32 s64, 7
  s_cbranch_scc1 L_p4_idle
  s_lshr_b32 s70, s36, 2
  s_lshl_b32 s69, s62, 2
  s_add_u32 s69, s69, s57
  s_lshl_b32 s68, s69, 15
  s_lshl_b32 s64, s70, 14
  s_add_u32 s68, s68, s64
  s_add_u32 s68, s68, 8388608
  s_mul_i32 s74, s69, 112
  s_lshl_b32 s64, s63, 3
  s_add_u32 s74, s74, s64
  s_lshl_b32 s64, s70, 1
  s_add_u32 s74, s74, s64
  s_lshl_b32 s74, s74, 10
  s_add_u32 s74, s74, 12582912
  s_mov_b32 s72, 0xc0135761
  s_mov_b32 s73, 0xbdd2d3e8
  s_lshl_b32 s64, s36, 13
  s_add_u32 s64, s64, 98304
  v_add_u32 v12, s64, v2
  s_xor_b32 s64, s36, 4
  s_lshl_b32 s64, s64, 13
  s_add_u32 s64, s64, 98304
  v_add_u32 v13, s64, v2
  v_mov_b32 v14, s72
  v_and_b32 v5, 31, v1
  v_lshlrev_b32 v5, 4, v5
  v_lshrrev_b32 v6, 5, v1
  v_lshlrev_b32 v6, 17, v6
  v_add_u32 v15, v5, v6
  v_and_b32 v16, 15, v1
  v_lshrrev_b32 v17, 2, v16
  v_lshrrev_b32 v18, 5, v1
  v_lshlrev_b32 v18, 2, v18
  v_add_u32 v17, v17, v18
  v_lshlrev_b32 v20, 7, v17
  v_and_b32 v17, 3, v16
  v_lshlrev_b32 v17, 3, v17
  v_add_u32 v20, v20, v17
  v_and_b32 v17, 16, v1
  v_lshlrev_b32 v17, 9, v17
  v_add_u32 v20, v20, v17
  s_lshl_b32 s64, s70, 12
  v_add_u32 v20, s64, v20
  v_lshrrev_b32 v17, 3, v16
  v_lshrrev_b32 v18, 3, v1
  v_and_b32 v18, 2, v18
  v_or_b32 v21, v17, v18
  s_lshl_b32 s64, s70, 1
  v_xor_b32 v21, s64, v21
  v_xor_b32 v17, 0, v21
  v_lshlrev_b32 v17, 5, v17
  v_add_u32 v4, v20, v17
  v_xor_b32 v17, 1, v21
  v_lshlrev_b32 v17, 5, v17
  v_add_u32 v5, v20, v17
  v_xor_b32 v17, 2, v21
  v_lshlrev_b32 v17, 5, v17
  v_add_u32 v6, v20, v17
  v_xor_b32 v17, 3, v21
  v_lshlrev_b32 v17, 5, v17
  v_add_u32 v7, v20, v17
  v_add_u32 v8, 0x10000, v4
  v_add_u32 v9, 0x10000, v5
  v_add_u32 v10, 0x10000, v6
  v_add_u32 v11, 0x10000, v7
  s_cmp_lg_u32 s36, 0
  s_nop 1
  s_cbranch_scc1 L_p4_nopoll
  s_lshl_b32 s78, s62, 11
  s_add_u32 s78, s78, 20185088
  v_lshlrev_b32 v240, 6, v1
  s_mov_b32 exec_lo, 0xffff
  s_mov_b32 exec_hi, 0
  s_mov_b32 s79, 0
  s_waitcnt vmcnt(0)
  buffer_load_dword v241, v240, s[48:51], s78 offen sc1
  s_sleep 3
  buffer_load_dword v242, v240, s[48:51], s78 offen sc1
L_wfp4_poll:
  s_waitcnt vmcnt(1)
  v_cmp_ne_u32 vcc, s56, v241
  s_cbranch_vccz L_wfp4_out
  buffer_load_dword v241, v240, s[48:51], s78 offen sc1
  s_waitcnt vmcnt(1)
  v_cmp_ne_u32 vcc, s56, v242
  s_cbranch_vccz L_wfp4_out
  buffer_load_dword v242, v240, s[48:51], s78 offen sc1
  s_add_u32 s79, s79, 1
  s_cmp_gt_u32 s79, 0x40000
  s_cbranch_scc0 L_wfp4_poll
L_wfp4_out:
  s_mov_b64 exec, -1
L_p4_nopoll:
  s_barrier
  s_lshl_b32 s64, s69, 9
  s_add_u32 s64, s64, 10485760
  s_add_u32 s65, s64, 0
  buffer_load_dwordx4 v[160:163], v15, s[48:51], s65 offen sc1
  s_add_u32 s65, s64, 32768
  buffer_load_dwordx4 v[164:167], v15, s[48:51], s65 offen sc1
  s_add_u32 s65, s64, 65536
  buffer_load_dwordx4 v[168:171], v15, s[48:51], s65 offen sc1
  s_add_u32 s65, s64, 98304
  buffer_load_dwordx4 v[172:175], v15, s[48:51], s65 offen sc1
  s_add_u32 s71, s75, 0
  s_and_b32 s71, s71, 7
  s_lshl_b32 s71, s71, 11
  s_add_u32 s71, s71, s68
  buffer_load_dwordx4 v[192:195], v2, s[48:51], s71 offen offset:0 sc1
  buffer_load_dwordx4 v[196:199], v2, s[48:51], s71 offen offset:1024 sc1
  s_add_u32 s71, s75, 1
  s_and_b32 s71, s71, 7
  s_lshl_b32 s71, s71, 11
  s_add_u32 s71, s71, s68
  buffer_load_dwordx4 v[200:203], v2, s[48:51], s71 offen offset:0 sc1
  buffer_load_dwordx4 v[204:207], v2, s[48:51], s71 offen offset:1024 sc1
  s_waitcnt vmcnt(4)
  v_add_f32 v16, v160, v162
  v_add_f32 v17, v161, v163
  v_add_f32 v16, v16, v164
  v_add_f32 v17, v17, v165
  v_add_f32 v16, v16, v166
  v_add_f32 v17, v17, v167
  v_add_f32 v16, v16, v168
  v_add_f32 v17, v17, v169
  v_add_f32 v16, v16, v170
  v_add_f32 v17, v17, v171
  v_add_f32 v16, v16, v172
  v_add_f32 v17, v17, v173
  v_add_f32 v16, v16, v174
  v_add_f32 v17, v17, v175
  v_mov_b32 v18, v16
  v_mov_b32 v19, v17
  s_nop 0
  v_permlane32_swap_b32 v18, v16
  v_permlane32_swap_b32 v19, v17
  v_add_f32 v16, v16, v18
  v_add_f32 v17, v17, v19
  v_mul_f32 v16, 0x3b000000, v16
  v_mul_f32 v17, 0x3b000000, v17
  v_fma_f32 v17, -v16, v16, v17
  v_max_f32 v17, 0, v17
  v_add_f32 v17, 0x3727c5ac, v17
  v_rsq_f32 v24, v17
  s_nop 0
  v_mul_f32 v26, v16, v24
  v_sub_f32 v26, 0, v26
  s_waitcnt vmcnt(3)
  v_lshlrev_b32 v16, 16, v192
  v_and_b32 v17, 0xffff0000, v192
  v_lshlrev_b32 v18, 16, v193
  v_and_b32 v19, 0xffff0000, v193
  v_lshlrev_b32 v20, 16, v194
  v_and_b32 v21, 0xffff0000, v194
  v_lshlrev_b32 v22, 16, v195
  v_and_b32 v23, 0xffff0000, v195
  v_fma_f32 v16, v16, v24, v26
  v_fma_f32 v17, v17, v24, v26
  v_fma_f32 v18, v18, v24, v26
  v_fma_f32 v19, v19, v24, v26
  v_fma_f32 v20, v20, v24, v26
  v_fma_f32 v21, v21, v24, v26
  v_fma_f32 v22, v22, v24, v26
  v_fma_f32 v23, v23, v24, v26
  v_cvt_pk_bf16_f32 v192, v16, v17
  v_cvt_pk_bf16_f32 v193, v18, v19
  v_cvt_pk_bf16_f32 v194, v20, v21
  v_cvt_pk_bf16_f32 v195, v22, v23
  s_barrier
  ds_read_b64_tr_b16 v[160:161], v4 offset:0
  ds_read_b64_tr_b16 v[162:163], v4 offset:1024
  ds_read_b64_tr_b16 v[164:165], v5 offset:0
  ds_read_b64_tr_b16 v[166:167], v5 offset:1024
  ds_read_b64_tr_b16 v[168:169], v6 offset:0
  ds_read_b64_tr_b16 v[170:171], v6 offset:1024
  ds_read_b64_tr_b16 v[172:173], v7 offset:0
  ds_read_b64_tr_b16 v[174:175], v7 offset:1024
  s_waitcnt lgkmcnt(6)
  v_mfma_f32_32x32x16_bf16 v[32:47], v[160:163], v[192:195], 0
  ds_read_b64_tr_b16 v[176:177], v4 offset:2048
  ds_read_b64_tr_b16 v[178:179], v4 offset:3072
  s_waitcnt vmcnt(2)
  v_lshlrev_b32 v16, 16, v196
  v_and_b32 v17, 0xffff0000, v196
  v_lshlrev_b32 v18, 16, v197
  v_and_b32 v19, 0xffff0000, v197
  v_lshlrev_b32 v20, 16, v198
  s_waitcnt lgkmcnt(6)
  v_mfma_f32_32x32x16_bf16 v[48:63], v[164:167], v[192:195], 0
  ds_read_b64_tr_b16 v[180:181], v5 offset:2048
  ds_read_b64_tr_b16 v[182:183], v5 offset:3072
  v_and_b32 v21, 0xffff0000, v198
  v_lshlrev_b32 v22, 16, v199
  v_and_b32 v23, 0xffff0000, v199
  v_fma_f32 v16, v16, v24, v26
  v_fma_f32 v17, v17, v24, v26
  s_add_u32 s71, s75, 2
  s_and_b32 s71, s71, 7
  s_lshl_b32 s71, s71, 11
  s_add_u32 s71, s71, s68
  buffer_load_dwordx4 v[208:211], v2, s[48:51], s71 offen offset:0 sc1
  s_waitcnt lgkmcnt(6)
  v_mfma_f32_32x32x16_bf16 v[64:79], v[168:171], v[192:195], 0
  ds_read_b64_tr_b16 v[184:185], v6 offset:2048
  ds_read_b64_tr_b16 v[186:187], v6 offset:3072
  v_fma_f32 v18, v18, v24, v26
  v_fma_f32 v19, v19, v24, v26
  v_fma_f32 v20, v20, v24, v26
  v_fma_f32 v21, v21, v24, v26
  v_fma_f32 v22, v22, v24, v26
  s_waitcnt lgkmcnt(6)
  v_mfma_f32_32x32x16_bf16 v[80:95], v[172:175], v[192:195], 0
  ds_read_b64_tr_b16 v[188:189], v7 offset:2048
  ds_read_b64_tr_b16 v[190:191], v7 offset:3072
  v_fma_f32 v23, v23, v24, v26
  v_cvt_pk_bf16_f32 v196, v16, v17
  v_cvt_pk_bf16_f32 v197, v18, v19
  v_cvt_pk_bf16_f32 v198, v20, v21
  v_cvt_pk_bf16_f32 v199, v22, v23
  s_waitcnt lgkmcnt(6)
  s_nop 0
  v_mfma_f32_32x32x16_bf16 v[32:47], v[176:179], v[196:199], v[32:47]
  ds_read_b64_tr_b16 v[160:161], v4 offset:16384
  ds_read_b64_tr_b16 v[162:163], v4 offset:17408
  s_waitcnt vmcnt(2)
  v_lshlrev_b32 v16, 16, v200
  v_and_b32 v17, 0xffff0000, v200
  v_lshlrev_b32 v18, 16, v201
  v_and_b32 v19, 0xffff0000, v201
  v_lshlrev_b32 v20, 16, v202
  s_waitcnt lgkmcnt(6)
  v_mfma_f32_32x32x16_bf16 v[48:63], v[180:183], v[196:199], v[48:63]
  ds_read_b64_tr_b16 v[164:165], v5 offset:16384
  ds_read_b64_tr_b16 v[166:167], v5 offset:17408
  v_and_b32 v21, 0xffff0000, v202
  v_lshlrev_b32 v22, 16, v203
  v_and_b32 v23, 0xffff0000, v203
  v_fma_f32 v16, v16, v24, v26
  v_fma_f32 v17, v17, v24, v26
  buffer_load_dwordx4 v[212:215], v2, s[48:51], s71 offen offset:1024 sc1
  s_waitcnt lgkmcnt(6)
  v_mfma_f32_32x32x16_bf16 v[64:79], v[184:187], v[196:199], v[64:79]
  ds_read_b64_tr_b16 v[168:169], v6 offset:16384
  ds_read_b64_tr_b16 v[170:171], v6 offset:17408
  v_fma_f32 v18, v18, v24, v26
  v_fma_f32 v19, v19, v24, v26
  v_fma_f32 v20, v20, v24, v26
  v_fma_f32 v21, v21, v24, v26
  v_fma_f32 v22, v22, v24, v26
  s_waitcnt lgkmcnt(6)
  v_mfma_f32_32x32x16_bf16 v[80:95], v[188:191], v[196:199], v[80:95]
  ds_read_b64_tr_b16 v[172:173], v7 offset:16384
  ds_read_b64_tr_b16 v[174:175], v7 offset:17408
  v_fma_f32 v23, v23, v24, v26
  v_cvt_pk_bf16_f32 v200, v16, v17
  v_cvt_pk_bf16_f32 v201, v18, v19
  v_cvt_pk_bf16_f32 v202, v20, v21
  v_cvt_pk_bf16_f32 v203, v22, v23
  s_waitcnt lgkmcnt(6)
  s_nop 0
  v_mfma_f32_32x32x16_bf16 v[32:47], v[160:163], v[200:203], v[32:47]
  ds_read_b64_tr_b16 v[176:177], v4 offset:18432
  ds_read_b64_tr_b16 v[178:179], v4 offset:19456
  s_waitcnt vmcnt(2)
  v_lshlrev_b32 v16, 16, v204
  v_and_b32 v17, 0xffff0000, v204
  v_lshlrev_b32 v18, 16, v205
  v_and_b32 v19, 0xffff0000, v205
  v_lshlrev_b32 v20, 16, v206
  s_waitcnt lgkmcnt(6)
  v_mfma_f32_32x32x16_bf16 v[48:63], v[164:167], v[200:203], v[48:63]
  ds_read_b64_tr_b16 v[180:181], v5 offset:18432
  ds_read_b64_tr_b16 v[182:183], v5 offset:19456
  v_and_b32 v21, 0xffff0000, v206
  v_lshlrev_b32 v22, 16, v207
  v_and_b32 v23, 0xffff0000, v207
  v_fma_f32 v16, v16, v24, v26
  v_fma_f32 v17, v17, v24, v26
  s_add_u32 s71, s75, 3
  s_and_b32 s71, s71, 7
  s_lshl_b32 s71, s71, 11
  s_add_u32 s71, s71, s68
  buffer_load_dwordx4 v[216:219], v2, s[48:51], s71 offen offset:0 sc1
  s_waitcnt lgkmcnt(6)
  v_mfma_f32_32x32x16_bf16 v[64:79], v[168:171], v[200:203], v[64:79]
  ds_read_b64_tr_b16 v[184:185], v6 offset:18432
  ds_read_b64_tr_b16 v[186:187], v6 offset:19456
  v_fma_f32 v18, v18, v24, v26
  v_fma_f32 v19, v19, v24, v26
  v_fma_f32 v20, v20, v24, v26
  v_fma_f32 v21, v21, v24, v26
  v_fma_f32 v22, v22, v24, v26
  s_waitcnt lgkmcnt(6)
  v_mfma_f32_32x32x16_bf16 v[80:95], v[172:175], v[200:203], v[80:95]
  ds_read_b64_tr_b16 v[188:189], v7 offset:18432
  ds_read_b64_tr_b16 v[190:191], v7 offset:19456
  v_fma_f32 v23, v23, v24, v26
  v_cvt_pk_bf16_f32 v204, v16, v17
  v_cvt_pk_bf16_f32 v205, v18, v19
  v_cvt_pk_bf16_f32 v206, v20, v21
  v_cvt_pk_bf16_f32 v207, v22, v23
  s_waitcnt lgkmcnt(6)
  s_nop 0
  v_mfma_f32_32x32x16_bf16 v[32:47], v[176:179], v[204:207], v[32:47]
  s_barrier
  ds_read_b64_tr_b16 v[160:161], v4 offset:32768
  ds_read_b64_tr_b16 v[162:163], v4 offset:33792
  s_waitcnt vmcnt(2)
  v_lshlrev_b32 v16, 16, v208
  v_and_b32 v17, 0xffff0000, v208
  v_lshlrev_b32 v18, 16, v209
  v_and_b32 v19, 0xffff0000, v209
  v_lshlrev_b32 v20, 16, v210
  s_waitcnt lgkmcnt(6)
  v_mfma_f32_32x32x16_bf16 v[48:63], v[180:183], v[204:207], v[48:63]
  ds_read_b64_tr_b16 v[164:165], v5 offset:32768
  ds_read_b64_tr_b16 v[166:167], v5 offset:33792
  v_and_b32 v21, 0xffff0000, v210
  v_lshlrev_b32 v22, 16, v211
  v_and_b32 v23, 0xffff0000, v211
  v_fma_f32 v16, v16, v24, v26
  v_fma_f32 v17, v17, v24, v26
  buffer_load_dwordx4 v[220:223], v2, s[48:51], s71 offen offset:1024 sc1
  s_waitcnt lgkmcnt(6)
  v_mfma_f32_32x32x16_bf16 v[64:79], v[184:187], v[204:207], v[64:79]
  ds_read_b64_tr_b16 v[168:169], v6 offset:32768
  ds_read_b64_tr_b16 v[170:171], v6 offset:33792
  v_fma_f32 v18, v18, v24, v26
  v_fma_f32 v19, v19, v24, v26
  v_fma_f32 v20, v20, v24, v26
  v_fma_f32 v21, v21, v24, v26
  v_fma_f32 v22, v22, v24, v26
  s_waitcnt lgkmcnt(6)
  v_mfma_f32_32x32x16_bf16 v[80:95], v[188:191], v[204:207], v[80:95]
  ds_read_b64_tr_b16 v[172:173], v7 offset:32768
  ds_read_b64_tr_b16 v[174:175], v7 offset:33792
  v_fma_f32 v23, v23, v24, v26
  v_cvt_pk_bf16_f32 v208, v16, v17
  v_cvt_pk_bf16_f32 v209, v18, v19
  v_cvt_pk_bf16_f32 v210, v20, v21
  v_cvt_pk_bf16_f32 v211, v22, v23
  s_waitcnt lgkmcnt(6)
  s_nop 0
  v_mfma_f32_32x32x16_bf16 v[32:47], v[160:163], v[208:211], v[32:47]
  ds_read_b64_tr_b16 v[176:177], v4 offset:34816
  ds_read_b64_tr_b16 v[178:179], v4 offset:35840
  s_waitcnt vmcnt(2)
  v_lshlrev_b32 v16, 16, v212
  v_and_b32 v17, 0xffff0000, v212
  v_lshlrev_b32 v18, 16, v213
  v_and_b32 v19, 0xffff0000, v213
  v_lshlrev_b32 v20, 16, v214
  s_waitcnt lgkmcnt(6)
  v_mfma_f32_32x32x16_bf16 v[48:63], v[164:167], v[208:211], v[48:63]
  ds_read_b64_tr_b16 v[180:181], v5 offset:34816
  ds_read_b64_tr_b16 v[182:183], v5 offset:35840
  v_and_b32 v21, 0xffff0000, v214
  v_lshlrev_b32 v22, 16, v215
  v_and_b32 v23, 0xffff0000, v215
  v_fma_f32 v16, v16, v24, v26
  v_fma_f32 v17, v17, v24, v26
  s_add_u32 s71, s75, 4
  s_and_b32 s71, s71, 7
  s_lshl_b32 s71, s71, 11
  s_add_u32 s71, s71, s68
  buffer_load_dwordx4 v[224:227], v2, s[48:51], s71 offen offset:0 sc1
  s_waitcnt lgkmcnt(6)
  v_mfma_f32_32x32x16_bf16 v[64:79], v[168:171], v[208:211], v[64:79]
  ds_read_b64_tr_b16 v[184:185], v6 offset:34816
  ds_read_b64_tr_b16 v[186:187], v6 offset:35840
  v_fma_f32 v18, v18, v24, v26
  v_fma_f32 v19, v19, v24, v26
  v_fma_f32 v20, v20, v24, v26
  v_fma_f32 v21, v21, v24, v26
  v_fma_f32 v22, v22, v24, v26
  s_waitcnt lgkmcnt(6)
  v_mfma_f32_32x32x16_bf16 v[80:95], v[172:175], v[208:211], v[80:95]
  ds_read_b64_tr_b16 v[188:189], v7 offset:34816
  ds_read_b64_tr_b16 v[190:191], v7 offset:35840
  v_fma_f32 v23, v23, v24, v26
  v_cvt_pk_bf16_f32 v212, v16, v17
  v_cvt_pk_bf16_f32 v213, v18, v19
  v_cvt_pk_bf16_f32 v214, v20, v21
  v_cvt_pk_bf16_f32 v215, v22, v23
  s_waitcnt lgkmcnt(6)
  s_nop 0
  v_mfma_f32_32x32x16_bf16 v[32:47], v[176:179], v[212:215], v[32:47]
  ds_read_b64_tr_b16 v[160:161], v4 offset:49152
  ds_read_b64_tr_b16 v[162:163], v4 offset:50176
  s_waitcnt vmcnt(2)
  v_lshlrev_b32 v16, 16, v216
  v_and_b32 v17, 0xffff0000, v216
  v_lshlrev_b32 v18, 16, v217
  v_and_b32 v19, 0xffff0000, v217
  v_lshlrev_b32 v20, 16, v218
  s_waitcnt lgkmcnt(6)
  v_mfma_f32_32x32x16_bf16 v[48:63], v[180:183], v[212:215], v[48:63]
  ds_read_b64_tr_b16 v[164:165], v5 offset:49152
  ds_read_b64_tr_b16 v[166:167], v5 offset:50176
  v_and_b32 v21, 0xffff0000, v218
  v_lshlrev_b32 v22, 16, v219
  v_and_b32 v23, 0xffff0000, v219
  v_fma_f32 v16, v16, v24, v26
  v_fma_f32 v17, v17, v24, v26
  buffer_load_dwordx4 v[228:231], v2, s[48:51], s71 offen offset:1024 sc1
  s_waitcnt lgkmcnt(6)
  v_mfma_f32_32x32x16_bf16 v[64:79], v[184:187], v[212:215], v[64:79]
  ds_read_b64_tr_b16 v[168:169], v6 offset:49152
  ds_read_b64_tr_b16 v[170:171], v6 offset:50176
  v_fma_f32 v18, v18, v24, v26
  v_fma_f32 v19, v19, v24, v26
  v_fma_f32 v20, v20, v24, v26
  v_fma_f32 v21, v21, v24, v26
  v_fma_f32 v22, v22, v24, v26
  s_waitcnt lgkmcnt(6)
  v_mfma_f32_32x32x16_bf16 v[80:95], v[188:191], v[212:215], v[80:95]
  ds_read_b64_tr_b16 v[172:173], v7 offset:49152
  ds_read_b64_tr_b16 v[174:175], v7 offset:50176
  v_fma_f32 v23, v23, v24, v26
  v_cvt_pk_bf16_f32 v216, v16, v17
  v_cvt_pk_bf16_f32 v217, v18, v19
  v_cvt_pk_bf16_f32 v218, v20, v21
  v_cvt_pk_bf16_f32 v219, v22, v23
  s_waitcnt lgkmcnt(6)
  s_nop 0
  v_mfma_f32_32x32x16_bf16 v[32:47], v[160:163], v[216:219], v[32:47]
  ds_read_b64_tr_b16 v[176:177], v4 offset:51200
  ds_read_b64_tr_b16 v[178:179], v4 offset:52224
  s_waitcnt vmcnt(2)
  v_lshlrev_b32 v16, 16, v220
  v_and_b32 v17, 0xffff0000, v220
  v_lshlrev_b32 v18, 16, v221
  v_and_b32 v19, 0xffff0000, v221
  v_lshlrev_b32 v20, 16, v222
  s_waitcnt lgkmcnt(6)
  v_mfma_f32_32x32x16_bf16 v[48:63], v[164:167], v[216:219], v[48:63]
  ds_read_b64_tr_b16 v[180:181], v5 offset:51200
  ds_read_b64_tr_b16 v[182:183], v5 offset:52224
  v_and_b32 v21, 0xffff0000, v222
  v_lshlrev_b32 v22, 16, v223
  v_and_b32 v23, 0xffff0000, v223
  v_fma_f32 v16, v16, v24, v26
  v_fma_f32 v17, v17, v24, v26
  s_add_u32 s71, s75, 5
  s_and_b32 s71, s71, 7
  s_lshl_b32 s71, s71, 11
  s_add_u32 s71, s71, s68
  buffer_load_dwordx4 v[232:235], v2, s[48:51], s71 offen offset:0 sc1
  s_waitcnt lgkmcnt(6)
  v_mfma_f32_32x32x16_bf16 v[64:79], v[168:171], v[216:219], v[64:79]
  ds_read_b64_tr_b16 v[184:185], v6 offset:51200
  ds_read_b64_tr_b16 v[186:187], v6 offset:52224
  v_fma_f32 v18, v18, v24, v26
  v_fma_f32 v19, v19, v24, v26
  v_fma_f32 v20, v20, v24, v26
  v_fma_f32 v21, v21, v24, v26
  v_fma_f32 v22, v22, v24, v26
  s_waitcnt lgkmcnt(6)
  v_mfma_f32_32x32x16_bf16 v[80:95], v[172:175], v[216:219], v[80:95]
  ds_read_b64_tr_b16 v[188:189], v7 offset:51200
  ds_read_b64_tr_b16 v[190:191], v7 offset:52224
  v_fma_f32 v23, v23, v24, v26
  v_cvt_pk_bf16_f32 v220, v16, v17
  v_cvt_pk_bf16_f32 v221, v18, v19
  v_cvt_pk_bf16_f32 v222, v20, v21
  v_cvt_pk_bf16_f32 v223, v22, v23
  s_waitcnt lgkmcnt(6)
  s_nop 0
  v_mfma_f32_32x32x16_bf16 v[32:47], v[176:179], v[220:223], v[32:47]
  s_barrier
  ds_read_b64_tr_b16 v[160:161], v8 offset:0
  ds_read_b64_tr_b16 v[162:163], v8 offset:1024
  s_waitcnt vmcnt(2)
  v_lshlrev_b32 v16, 16, v224
  v_and_b32 v17, 0xffff0000, v224
  v_lshlrev_b32 v18, 16, v225
  v_and_b32 v19, 0xffff0000, v225
  v_lshlrev_b32 v20, 16, v226
  s_waitcnt lgkmcnt(6)
  v_mfma_f32_32x32x16_bf16 v[48:63], v[180:183], v[220:223], v[48:63]
  ds_read_b64_tr_b16 v[164:165], v9 offset:0
  ds_read_b64_tr_b16 v[166:167], v9 offset:1024
  v_and_b32 v21, 0xffff0000, v226
  v_lshlrev_b32 v22, 16, v227
  v_and_b32 v23, 0xffff0000, v227
  v_fma_f32 v16, v16, v24, v26
  v_fma_f32 v17, v17, v24, v26
  buffer_load_dwordx4 v[236:239], v2, s[48:51], s71 offen offset:1024 sc1
  s_waitcnt lgkmcnt(6)
  v_mfma_f32_32x32x16_bf16 v[64:79], v[184:187], v[220:223], v[64:79]
  ds_read_b64_tr_b16 v[168:169], v10 offset:0
  ds_read_b64_tr_b16 v[170:171], v10 offset:1024
  v_fma_f32 v18, v18, v24, v26
  v_fma_f32 v19, v19, v24, v26
  v_fma_f32 v20, v20, v24, v26
  v_fma_f32 v21, v21, v24, v26
  v_fma_f32 v22, v22, v24, v26
  s_waitcnt lgkmcnt(6)
  v_mfma_f32_32x32x16_bf16 v[80:95], v[188:191], v[220:223], v[80:95]
  ds_read_b64_tr_b16 v[172:173], v11 offset:0
  ds_read_b64_tr_b16 v[174:175], v11 offset:1024
  v_fma_f32 v23, v23, v24, v26
  v_cvt_pk_bf16_f32 v224, v16, v17
  v_cvt_pk_bf16_f32 v225, v18, v19
  v_cvt_pk_bf16_f32 v226, v20, v21
  v_cvt_pk_bf16_f32 v227, v22, v23
  s_waitcnt lgkmcnt(6)
  s_nop 0
  v_mfma_f32_32x32x16_bf16 v[32:47], v[160:163], v[224:227], v[32:47]
  ds_read_b64_tr_b16 v[176:177], v8 offset:2048
  ds_read_b64_tr_b16 v[178:179], v8 offset:3072
  s_waitcnt vmcnt(2)
  v_lshlrev_b32 v16, 16, v228
  v_and_b32 v17, 0xffff0000, v228
  v_lshlrev_b32 v18, 16, v229
  v_and_b32 v19, 0xffff0000, v229
  v_lshlrev_b32 v20, 16, v230
  s_waitcnt lgkmcnt(6)
  v_mfma_f32_32x32x16_bf16 v[48:63], v[164:167], v[224:227], v[48:63]
  ds_read_b64_tr_b16 v[180:181], v9 offset:2048
  ds_read_b64_tr_b16 v[182:183], v9 offset:3072
  v_and_b32 v21, 0xffff0000, v230
  v_lshlrev_b32 v22, 16, v231
  v_and_b32 v23, 0xffff0000, v231
  v_fma_f32 v16, v16, v24, v26
  v_fma_f32 v17, v17, v24, v26
  s_add_u32 s71, s75, 6
  s_and_b32 s71, s71, 7
  s_lshl_b32 s71, s71, 11
  s_add_u32 s71, s71, s68
  buffer_load_dwordx4 v[240:243], v2, s[48:51], s71 offen offset:0 sc1
  s_waitcnt lgkmcnt(6)
  v_mfma_f32_32x32x16_bf16 v[64:79], v[168:171], v[224:227], v[64:79]
  ds_read_b64_tr_b16 v[184:185], v10 offset:2048
  ds_read_b64_tr_b16 v[186:187], v10 offset:3072
  v_fma_f32 v18, v18, v24, v26
  v_fma_f32 v19, v19, v24, v26
  v_fma_f32 v20, v20, v24, v26
  v_fma_f32 v21, v21, v24, v26
  v_fma_f32 v22, v22, v24, v26
  s_waitcnt lgkmcnt(6)
  v_mfma_f32_32x32x16_bf16 v[80:95], v[172:175], v[224:227], v[80:95]
  ds_read_b64_tr_b16 v[188:189], v11 offset:2048
  ds_read_b64_tr_b16 v[190:191], v11 offset:3072
  v_fma_f32 v23, v23, v24, v26
  v_cvt_pk_bf16_f32 v228, v16, v17
  v_cvt_pk_bf16_f32 v229, v18, v19
  v_cvt_pk_bf16_f32 v230, v20, v21
  v_cvt_pk_bf16_f32 v231, v22, v23
  s_waitcnt lgkmcnt(6)
  s_nop 0
  v_mfma_f32_32x32x16_bf16 v[32:47], v[176:179], v[228:231], v[32:47]
  ds_read_b64_tr_b16 v[160:161], v8 offset:16384
  ds_read_b64_tr_b16 v[162:163], v8 offset:17408
  s_waitcnt vmcnt(2)
  v_lshlrev_b32 v16, 16, v232
  v_and_b32 v17, 0xffff0000, v232
  v_lshlrev_b32 v18, 16, v233
  v_and_b32 v19, 0xffff0000, v233
  v_lshlrev_b32 v20, 16, v234
  s_waitcnt lgkmcnt(6)
  v_mfma_f32_32x32x16_bf16 v[48:63], v[180:183], v[228:231], v[48:63]
  s_add_u32 s76, s75, 0
  s_and_b32 s76, s76, 7
  s_mul_i32 s76, s76, 114688
  s_add_u32 s76, s76, s66
  s_add_u32 s76, s76, 128
  s_mov_b32 m0, s67
  s_nop 0
  buffer_load_dwordx4 v3, s[40:43], s76 offen lds
  s_add_u32 s76, s76, 28672
  s_add_u32 m0, s67, 1024
  s_nop 0
  buffer_load_dwordx4 v3, s[40:43], s76 offen lds
  ds_read_b64_tr_b16 v[164:165], v9 offset:16384
  ds_read_b64_tr_b16 v[166:167], v9 offset:17408
  v_and_b32 v21, 0xffff0000, v234
  v_lshlrev_b32 v22, 16, v235
  v_and_b32 v23, 0xffff0000, v235
  v_fma_f32 v16, v16, v24, v26
  v_fma_f32 v17, v17, v24, v26
  buffer_load_dwordx4 v[244:247], v2, s[48:51], s71 offen offset:1024 sc1
  s_waitcnt lgkmcnt(6)
  v_mfma_f32_32x32x16_bf16 v[64:79], v[184:187], v[228:231], v[64:79]
  ds_read_b64_tr_b16 v[168:169], v10 offset:16384
  ds_read_b64_tr_b16 v[170:171], v10 offset:17408
  v_fma_f32 v18, v18, v24, v26
  v_fma_f32 v19, v19, v24, v26
  v_fma_f32 v20, v20, v24, v26
  v_fma_f32 v21, v21, v24, v26
  v_fma_f32 v22, v22, v24, v26
  s_waitcnt lgkmcnt(6)
  v_mfma_f32_32x32x16_bf16 v[80:95], v[188:191], v[228:231], v[80:95]
  ds_read_b64_tr_b16 v[172:173], v11 offset:16384
  ds_read_b64_tr_b16 v[174:175], v11 offset:17408
  v_fma_f32 v23, v23, v24, v26
  v_cvt_pk_bf16_f32 v232, v16, v17
  v_cvt_pk_bf16_f32 v233, v18, v19
  v_cvt_pk_bf16_f32 v234, v20, v21
  v_cvt_pk_bf16_f32 v235, v22, v23
  s_waitcnt lgkmcnt(6)
  s_nop 0
  v_mfma_f32_32x32x16_bf16 v[32:47], v[160:163], v[232:235], v[32:47]
  ds_read_b64_tr_b16 v[176:177], v8 offset:18432
  ds_read_b64_tr_b16 v[178:179], v8 offset:19456
  s_waitcnt vmcnt(4)
  v_lshlrev_b32 v16, 16, v236
  v_and_b32 v17, 0xffff0000, v236
  v_lshlrev_b32 v18, 16, v237
  v_and_b32 v19, 0xffff0000, v237
  v_lshlrev_b32 v20, 16, v238
  s_waitcnt lgkmcnt(6)
  v_mfma_f32_32x32x16_bf16 v[48:63], v[164:167], v[232:235], v[48:63]
  ds_read_b64_tr_b16 v[180:181], v9 offset:18432
  ds_read_b64_tr_b16 v[182:183], v9 offset:19456
  v_and_b32 v21, 0xffff0000, v238
  v_lshlrev_b32 v22, 16, v239
  v_and_b32 v23, 0xffff0000, v239
  v_fma_f32 v16, v16, v24, v26
  v_fma_f32 v17, v17, v24, v26
  s_add_u32 s71, s75, 7
  s_and_b32 s71, s71, 7
  s_lshl_b32 s71, s71, 11
  s_add_u32 s71, s71, s68
  buffer_load_dwordx4 v[248:251], v2, s[48:51], s71 offen offset:0 sc1
  s_waitcnt lgkmcnt(6)
  v_mfma_f32_32x32x16_bf16 v[64:79], v[168:171], v[232:235], v[64:79]
  ds_read_b64_tr_b16 v[184:185], v10 offset:18432
  ds_read_b64_tr_b16 v[186:187], v10 offset:19456
  v_fma_f32 v18, v18, v24, v26
  v_fma_f32 v19, v19, v24, v26
  v_fma_f32 v20, v20, v24, v26
  v_fma_f32 v21, v21, v24, v26
  v_fma_f32 v22, v22, v24, v26
  s_waitcnt lgkmcnt(6)
  v_mfma_f32_32x32x16_bf16 v[80:95], v[172:175], v[232:235], v[80:95]
  ds_read_b64_tr_b16 v[188:189], v11 offset:18432
  ds_read_b64_tr_b16 v[190:191], v11 offset:19456
  v_fma_f32 v23, v23, v24, v26
  v_cvt_pk_bf16_f32 v236, v16, v17
  v_cvt_pk_bf16_f32 v237, v18, v19
  v_cvt_pk_bf16_f32 v238, v20, v21
  v_cvt_pk_bf16_f32 v239, v22, v23
  s_waitcnt lgkmcnt(6)
  s_nop 0
  v_mfma_f32_32x32x16_bf16 v[32:47], v[176:179], v[236:239], v[32:47]
  ds_read_b64_tr_b16 v[160:161], v8 offset:32768
  ds_read_b64_tr_b16 v[162:163], v8 offset:33792
  s_waitcnt vmcnt(4)
  v_lshlrev_b32 v16, 16, v240
  v_and_b32 v17, 0xffff0000, v240
  v_lshlrev_b32 v18, 16, v241
  v_and_b32 v19, 0xffff0000, v241
  v_lshlrev_b32 v20, 16, v242
  s_waitcnt lgkmcnt(6)
  v_mfma_f32_32x32x16_bf16 v[48:63], v[180:183], v[236:239], v[48:63]
  s_add_u32 s76, s75, 1
  s_and_b32 s76, s76, 7
  s_mul_i32 s76, s76, 114688
  s_add_u32 s76, s76, s66
  s_add_u32 s76, s76, 128
  s_add_u32 m0, s67, 16384
  s_nop 0
  buffer_load_dwordx4 v3, s[40:43], s76 offen lds
  s_add_u32 s76, s76, 28672
  s_add_u32 m0, s67, 17408
  s_nop 0
  buffer_load_dwordx4 v3, s[40:43], s76 offen lds
  ds_read_b64_tr_b16 v[164:165], v9 offset:32768
  ds_read_b64_tr_b16 v[166:167], v9 offset:33792
  v_and_b32 v21, 0xffff0000, v242
  v_lshlrev_b32 v22, 16, v243
  v_and_b32 v23, 0xffff0000, v243
  v_fma_f32 v16, v16, v24, v26
  v_fma_f32 v17, v17, v24, v26
  buffer_load_dwordx4 v[252:255], v2, s[48:51], s71 offen offset:1024 sc1
  s_waitcnt lgkmcnt(6)
  v_mfma_f32_32x32x16_bf16 v[64:79], v[184:187], v[236:239], v[64:79]
  ds_read_b64_tr_b16 v[168:169], v10 offset:32768
  ds_read_b64_tr_b16 v[170:171], v10 offset:33792
  v_fma_f32 v18, v18, v24, v26
  v_fma_f32 v19, v19, v24, v26
  v_fma_f32 v20, v20, v24, v26
  v_fma_f32 v21, v21, v24, v26
  v_fma_f32 v22, v22, v24, v26
  s_waitcnt lgkmcnt(6)
  v_mfma_f32_32x32x16_bf16 v[80:95], v[188:191], v[236:239], v[80:95]
  ds_read_b64_tr_b16 v[172:173], v11 offset:32768
  ds_read_b64_tr_b16 v[174:175], v11 offset:33792
  v_fma_f32 v23, v23, v24, v26
  v_cvt_pk_bf16_f32 v240, v16, v17
  v_cvt_pk_bf16_f32 v241, v18, v19
  v_cvt_pk_bf16_f32 v242, v20, v21
  v_cvt_pk_bf16_f32 v243, v22, v23
  s_waitcnt lgkmcnt(6)
  s_nop 0
  v_mfma_f32_32x32x16_bf16 v[32:47], v[160:163], v[240:243], v[32:47]
  ds_read_b64_tr_b16 v[176:177], v8 offset:34816
  ds_read_b64_tr_b16 v[178:179], v8 offset:35840
  s_waitcnt vmcnt(4)
  v_lshlrev_b32 v16, 16, v244
  v_and_b32 v17, 0xffff0000, v244
  v_lshlrev_b32 v18, 16, v245
  v_and_b32 v19, 0xffff0000, v245
  v_lshlrev_b32 v20, 16, v246
  s_waitcnt lgkmcnt(6)
  v_mfma_f32_32x32x16_bf16 v[48:63], v[164:167], v[240:243], v[48:63]
  ds_read_b64_tr_b16 v[180:181], v9 offset:34816
  ds_read_b64_tr_b16 v[182:183], v9 offset:35840
  v_and_b32 v21, 0xffff0000, v246
  v_lshlrev_b32 v22, 16, v247
  v_and_b32 v23, 0xffff0000, v247
  v_fma_f32 v16, v16, v24, v26
  v_fma_f32 v17, v17, v24, v26
  s_waitcnt lgkmcnt(6)
  v_mfma_f32_32x32x16_bf16 v[64:79], v[168:171], v[240:243], v[64:79]
  ds_read_b64_tr_b16 v[184:185], v10 offset:34816
  ds_read_b64_tr_b16 v[186:187], v10 offset:35840
  v_fma_f32 v18, v18, v24, v26
  v_fma_f32 v19, v19, v24, v26
  v_fma_f32 v20, v20, v24, v26
  v_fma_f32 v21, v21, v24, v26
  v_fma_f32 v22, v22, v24, v26
  s_waitcnt lgkmcnt(6)
  v_mfma_f32_32x32x16_bf16 v[80:95], v[172:175], v[240:243], v[80:95]
  ds_read_b64_tr_b16 v[188:189], v11 offset:34816
  ds_read_b64_tr_b16 v[190:191], v11 offset:35840
  v_fma_f32 v23, v23, v24, v26
  v_cvt_pk_bf16_f32 v244, v16, v17
  v_cvt_pk_bf16_f32 v245, v18, v19
  v_cvt_pk_bf16_f32 v246, v20, v21
  v_cvt_pk_bf16_f32 v247, v22, v23
  s_waitcnt lgkmcnt(6)
  s_nop 0
  v_mfma_f32_32x32x16_bf16 v[32:47], v[176:179], v[244:247], v[32:47]
  ds_read_b64_tr_b16 v[160:161], v8 offset:49152
  ds_read_b64_tr_b16 v[162:163], v8 offset:50176
  s_waitcnt vmcnt(3)
  v_lshlrev_b32 v16, 16, v248
  v_and_b32 v17, 0xffff0000, v248
  v_lshlrev_b32 v18, 16, v249
  v_and_b32 v19, 0xffff0000, v249
  v_lshlrev_b32 v20, 16, v250
  s_waitcnt lgkmcnt(6)
  v_mfma_f32_32x32x16_bf16 v[48:63], v[180:183], v[244:247], v[48:63]
  s_add_u32 s76, s75, 2
  s_and_b32 s76, s76, 7
  s_mul_i32 s76, s76, 114688
  s_add_u32 s76, s76, s66
  s_add_u32 s76, s76, 128
  s_add_u32 m0, s67, 32768
  s_nop 0
  buffer_load_dwordx4 v3, s[40:43], s76 offen lds
  s_add_u32 s76, s76, 28672
  s_add_u32 m0, s67, 33792
  s_nop 0
  buffer_load_dwordx4 v3, s[40:43], s76 offen lds
  ds_read_b64_tr_b16 v[164:165], v9 offset:49152
  ds_read_b64_tr_b16 v[166:167], v9 offset:50176
  v_and_b32 v21, 0xffff0000, v250
  v_lshlrev_b32 v22, 16, v251
  v_and_b32 v23, 0xffff0000, v251
  v_fma_f32 v16, v16, v24, v26
  v_fma_f32 v17, v17, v24, v26
  s_waitcnt lgkmcnt(6)
  v_mfma_f32_32x32x16_bf16 v[64:79], v[184:187], v[244:247], v[64:79]
  ds_read_b64_tr_b16 v[168:169], v10 offset:49152
  ds_read_b64_tr_b16 v[170:171], v10 offset:50176
  v_fma_f32 v18, v18, v24, v26
  v_fma_f32 v19, v19, v24, v26
  v_fma_f32 v20, v20, v24, v26
  v_fma_f32 v21, v21, v24, v26
  v_fma_f32 v22, v22, v24, v26
  s_waitcnt lgkmcnt(6)
  v_mfma_f32_32x32x16_bf16 v[80:95], v[188:191], v[244:247], v[80:95]
  ds_read_b64_tr_b16 v[172:173], v11 offset:49152
  ds_read_b64_tr_b16 v[174:175], v11 offset:50176
  v_fma_f32 v23, v23, v24, v26
  v_cvt_pk_bf16_f32 v248, v16, v17
  v_cvt_pk_bf16_f32 v249, v18, v19
  v_cvt_pk_bf16_f32 v250, v20, v21
  v_cvt_pk_bf16_f32 v251, v22, v23
  s_waitcnt lgkmcnt(6)
  s_nop 0
  v_mfma_f32_32x32x16_bf16 v[32:47], v[160:163], v[248:251], v[32:47]
  ds_read_b64_tr_b16 v[176:177], v8 offset:51200
  ds_read_b64_tr_b16 v[178:179], v8 offset:52224
  s_waitcnt vmcnt(2)
  v_lshlrev_b32 v16, 16, v252
  v_and_b32 v17, 0xffff0000, v252
  v_lshlrev_b32 v18, 16, v253
  v_and_b32 v19, 0xffff0000, v253
  v_lshlrev_b32 v20, 16, v254
  s_waitcnt lgkmcnt(6)
  v_mfma_f32_32x32x16_bf16 v[48:63], v[164:167], v[248:251], v[48:63]
  ds_read_b64_tr_b16 v[180:181], v9 offset:51200
  ds_read_b64_tr_b16 v[182:183], v9 offset:52224
  v_and_b32 v21, 0xffff0000, v254
  v_lshlrev_b32 v22, 16, v255
  v_and_b32 v23, 0xffff0000, v255
  v_fma_f32 v16, v16, v24, v26
  v_fma_f32 v17, v17, v24, v26
  s_waitcnt lgkmcnt(6)
  v_mfma_f32_32x32x16_bf16 v[64:79], v[168:171], v[248:251], v[64:79]
  ds_read_b64_tr_b16 v[184:185], v10 offset:51200
  ds_read_b64_tr_b16 v[186:187], v10 offset:52224
  v_fma_f32 v18, v18, v24, v26
  v_fma_f32 v19, v19, v24, v26
  v_fma_f32 v20, v20, v24, v26
  v_fma_f32 v21, v21, v24, v26
  v_fma_f32 v22, v22, v24, v26
  s_waitcnt lgkmcnt(6)
  v_mfma_f32_32x32x16_bf16 v[80:95], v[172:175], v[248:251], v[80:95]
  ds_read_b64_tr_b16 v[188:189], v11 offset:51200
  ds_read_b64_tr_b16 v[190:191], v11 offset:52224
  v_fma_f32 v23, v23, v24, v26
  v_cvt_pk_bf16_f32 v252, v16, v17
  v_cvt_pk_bf16_f32 v253, v18, v19
  v_cvt_pk_bf16_f32 v254, v20, v21
  v_cvt_pk_bf16_f32 v255, v22, v23
  s_waitcnt lgkmcnt(6)
  s_nop 0
  v_mfma_f32_32x32x16_bf16 v[32:47], v[176:179], v[252:255], v[32:47]
  s_waitcnt lgkmcnt(0)
  s_barrier
  ds_read_b64_tr_b16 v[160:161], v4 offset:0
  ds_read_b64_tr_b16 v[162:163], v4 offset:1024
  v_mfma_f32_32x32x16_bf16 v[48:63], v[180:183], v[252:255], v[48:63]
  s_add_u32 s76, s75, 3
  s_and_b32 s76, s76, 7
  s_mul_i32 s76, s76, 114688
  s_add_u32 s76, s76, s66
  s_add_u32 s76, s76, 128
  s_add_u32 m0, s67, 49152
  s_nop 0
  buffer_load_dwordx4 v3, s[40:43], s76 offen lds
  s_add_u32 s76, s76, 28672
  s_add_u32 m0, s67, 50176
  s_nop 0
  buffer_load_dwordx4 v3, s[40:43], s76 offen lds
  ds_read_b64_tr_b16 v[164:165], v5 offset:0
  ds_read_b64_tr_b16 v[166:167], v5 offset:1024
  v_mfma_f32_32x32x16_bf16 v[64:79], v[184:187], v[252:255], v[64:79]
  ds_read_b64_tr_b16 v[168:169], v6 offset:0
  ds_read_b64_tr_b16 v[170:171], v6 offset:1024
  v_mfma_f32_32x32x16_bf16 v[80:95], v[188:191], v[252:255], v[80:95]
  ds_read_b64_tr_b16 v[172:173], v7 offset:0
  ds_read_b64_tr_b16 v[174:175], v7 offset:1024
  s_waitcnt lgkmcnt(6)
  v_mfma_f32_32x32x16_bf16 v[96:111], v[160:163], v[192:195], 0
  ds_read_b64_tr_b16 v[176:177], v4 offset:2048
  ds_read_b64_tr_b16 v[178:179], v4 offset:3072
  s_nop 2
  ds_write_b128 v12, v[64:67] offset:0
  s_waitcnt lgkmcnt(7)
  v_mfma_f32_32x32x16_bf16 v[112:127], v[164:167], v[192:195], 0
  ds_read_b64_tr_b16 v[180:181], v5 offset:2048
  ds_read_b64_tr_b16 v[182:183], v5 offset:3072
  ds_write_b128 v12, v[68:71] offset:1024
  s_waitcnt lgkmcnt(8)
  v_mfma_f32_32x32x16_bf16 v[128:143], v[168:171], v[192:195], 0
  ds_read_b64_tr_b16 v[184:185], v6 offset:2048
  ds_read_b64_tr_b16 v[186:187], v6 offset:3072
  ds_write_b128 v12, v[72:75] offset:2048
  s_waitcnt lgkmcnt(9)
  v_mfma_f32_32x32x16_bf16 v[144:159], v[172:175], v[192:195], 0
  ds_read_b64_tr_b16 v[188:189], v7 offset:2048
  ds_read_b64_tr_b16 v[190:191], v7 offset:3072
  ds_write_b128 v12, v[76:79] offset:3072
  s_waitcnt lgkmcnt(10)
  v_mfma_f32_32x32x16_bf16 v[96:111], v[176:179], v[196:199], v[96:111]
  ds_read_b64_tr_b16 v[160:161], v4 offset:16384
  ds_read_b64_tr_b16 v[162:163], v4 offset:17408
  ds_write_b128 v12, v[80:83] offset:4096
  s_waitcnt lgkmcnt(10)
  v_mfma_f32_32x32x16_bf16 v[112:127], v[180:183], v[196:199], v[112:127]
  s_add_u32 s76, s75, 4
  s_and_b32 s76, s76, 7
  s_mul_i32 s76, s76, 114688
  s_add_u32 s76, s76, s66
  s_add_u32 s76, s76, 128
  s_add_u32 m0, s67, 65536
  s_nop 0
  buffer_load_dwordx4 v3, s[40:43], s76 offen lds
  s_add_u32 s76, s76, 28672
  s_add_u32 m0, s67, 66560
  s_nop 0
  buffer_load_dwordx4 v3, s[40:43], s76 offen lds
  ds_read_b64_tr_b16 v[164:165], v5 offset:16384
  ds_read_b64_tr_b16 v[166:167], v5 offset:17408
  ds_write_b128 v12, v[84:87] offset:5120
  s_waitcnt lgkmcnt(10)
  v_mfma_f32_32x32x16_bf16 v[128:143], v[184:187], v[196:199], v[128:143]
  ds_read_b64_tr_b16 v[168:169], v6 offset:16384
  ds_read_b64_tr_b16 v[170:171], v6 offset:17408
  ds_write_b128 v12, v[88:91] offset:6144
  s_waitcnt lgkmcnt(10)
  v_mfma_f32_32x32x16_bf16 v[144:159], v[188:191], v[196:199], v[144:159]
  ds_read_b64_tr_b16 v[172:173], v7 offset:16384
  ds_read_b64_tr_b16 v[174:175], v7 offset:17408
  ds_write_b128 v12, v[92:95] offset:7168
  s_waitcnt lgkmcnt(10)
  v_mfma_f32_32x32x16_bf16 v[96:111], v[160:163], v[200:203], v[96:111]
  ds_read_b64_tr_b16 v[176:177], v4 offset:18432
  ds_read_b64_tr_b16 v[178:179], v4 offset:19456
  s_waitcnt lgkmcnt(9)
  v_mfma_f32_32x32x16_bf16 v[112:127], v[164:167], v[200:203], v[112:127]
  ds_read_b64_tr_b16 v[180:181], v5 offset:18432
  ds_read_b64_tr_b16 v[182:183], v5 offset:19456
  s_waitcnt lgkmcnt(8)
  v_mfma_f32_32x32x16_bf16 v[128:143], v[168:171], v[200:203], v[128:143]
  ds_read_b64_tr_b16 v[184:185], v6 offset:18432
  ds_read_b64_tr_b16 v[186:187], v6 offset:19456
  s_waitcnt lgkmcnt(7)
  v_mfma_f32_32x32x16_bf16 v[144:159], v[172:175], v[200:203], v[144:159]
  ds_read_b64_tr_b16 v[188:189], v7 offset:18432
  ds_read_b64_tr_b16 v[190:191], v7 offset:19456
  s_waitcnt lgkmcnt(6)
  v_mfma_f32_32x32x16_bf16 v[96:111], v[176:179], v[204:207], v[96:111]
  s_waitcnt vmcnt(2)
  s_barrier
  ds_read_b64_tr_b16 v[160:161], v4 offset:32768
  ds_read_b64_tr_b16 v[162:163], v4 offset:33792
  ds_read_b128 v[64:67], v13 offset:0
  ds_read_b128 v[68:71], v13 offset:1024
  ds_read_b128 v[72:75], v13 offset:2048
  ds_read_b128 v[76:79], v13 offset:3072
  s_waitcnt lgkmcnt(10)
  v_mfma_f32_32x32x16_bf16 v[112:127], v[180:183], v[204:207], v[112:127]
  s_add_u32 s76, s75, 5
  s_and_b32 s76, s76, 7
  s_mul_i32 s76, s76, 114688
  s_add_u32 s76, s76, s66
  s_add_u32 s76, s76, 128
  s_add_u32 m0, s67, 81920
  s_nop 0
  buffer_load_dwordx4 v3, s[40:43], s76 offen lds
  s_add_u32 s76, s76, 28672
  s_add_u32 m0, s67, 82944
  s_nop 0
  buffer_load_dwordx4 v3, s[40:43], s76 offen lds
  ds_read_b64_tr_b16 v[164:165], v5 offset:32768
  ds_read_b64_tr_b16 v[166:167], v5 offset:33792
  ds_read_b128 v[80:83], v13 offset:4096
  ds_read_b128 v[84:87], v13 offset:5120
  ds_read_b128 v[88:91], v13 offset:6144
  ds_read_b128 v[92:95], v13 offset:7168
  s_waitcnt lgkmcnt(14)
  v_mfma_f32_32x32x16_bf16 v[128:143], v[184:187], v[204:207], v[128:143]
  ds_read_b64_tr_b16 v[168:169], v6 offset:32768
  ds_read_b64_tr_b16 v[170:171], v6 offset:33792
  s_waitcnt lgkmcnt(2)
  v_add_f32 v32, v32, v64
  v_add_f32 v33, v33, v65
  v_add_f32 v34, v34, v66
  v_mfma_f32_32x32x16_bf16 v[144:159], v[188:191], v[204:207], v[144:159]
  ds_read_b64_tr_b16 v[172:173], v7 offset:32768
  ds_read_b64_tr_b16 v[174:175], v7 offset:33792
  v_add_f32 v35, v35, v67
  v_add_f32 v36, v36, v68
  v_add_f32 v37, v37, v69
  v_add_f32 v38, v38, v70
  v_mfma_f32_32x32x16_bf16 v[96:111], v[160:163], v[208:211], v[96:111]
  ds_read_b64_tr_b16 v[176:177], v4 offset:34816
  ds_read_b64_tr_b16 v[178:179], v4 offset:35840
  v_add_f32 v39, v39, v71
  v_add_f32 v40, v40, v72
  v_add_f32 v41, v41, v73
  v_add_f32 v42, v42, v74
  v_mfma_f32_32x32x16_bf16 v[112:127], v[164:167], v[208:211], v[112:127]
  ds_read_b64_tr_b16 v[180:181], v5 offset:34816
  ds_read_b64_tr_b16 v[182:183], v5 offset:35840
  v_add_f32 v43, v43, v75
  v_add_f32 v44, v44, v76
  v_add_f32 v45, v45, v77
  v_add_f32 v46, v46, v78
  s_waitcnt lgkmcnt(6)
  v_mfma_f32_32x32x16_bf16 v[128:143], v[168:171], v[208:211], v[128:143]
  ds_read_b64_tr_b16 v[184:185], v6 offset:34816
  ds_read_b64_tr_b16 v[186:187], v6 offset:35840
  v_add_f32 v47, v47, v79
  v_add_f32 v48, v48, v80
  v_add_f32 v49, v49, v81
  v_add_f32 v50, v50, v82
  s_waitcnt lgkmcnt(6)
  v_mfma_f32_32x32x16_bf16 v[144:159], v[172:175], v[208:211], v[144:159]
  ds_read_b64_tr_b16 v[188:189], v7 offset:34816
  ds_read_b64_tr_b16 v[190:191], v7 offset:35840
  v_add_f32 v51, v51, v83
  v_add_f32 v52, v52, v84
  v_add_f32 v53, v53, v85
  v_add_f32 v54, v54, v86
  s_waitcnt lgkmcnt(6)
  v_mfma_f32_32x32x16_bf16 v[96:111], v[176:179], v[212:215], v[96:111]
  ds_read_b64_tr_b16 v[160:161], v4 offset:49152
  ds_read_b64_tr_b16 v[162:163], v4 offset:50176
  v_add_f32 v55, v55, v87
  v_add_f32 v56, v56, v88
  v_add_f32 v57, v57, v89
  v_add_f32 v58, v58, v90
  s_waitcnt lgkmcnt(6)
  v_mfma_f32_32x32x16_bf16 v[112:127], v[180:183], v[212:215], v[112:127]
  s_add_u32 s76, s75, 6
  s_and_b32 s76, s76, 7
  s_mul_i32 s76, s76, 114688
  s_add_u32 s76, s76, s66
  s_add_u32 s76, s76, 128
  s_mov_b32 m0, s67
  s_nop 0
  buffer_load_dwordx4 v3, s[40:43], s76 offen lds
  s_add_u32 s76, s76, 28672
  s_add_u32 m0, s67, 1024
  s_nop 0
  buffer_load_dwordx4 v3, s[40:43], s76 offen lds
  ds_read_b64_tr_b16 v[164:165], v5 offset:49152
  ds_read_b64_tr_b16 v[166:167], v5 offset:50176
  v_add_f32 v59, v59, v91
  v_add_f32 v60, v60, v92
  v_add_f32 v61, v61, v93
  v_add_f32 v62, v62, v94
  s_waitcnt lgkmcnt(6)
  v_mfma_f32_32x32x16_bf16 v[128:143], v[184:187], v[212:215], v[128:143]
  ds_read_b64_tr_b16 v[168:169], v6 offset:49152
  ds_read_b64_tr_b16 v[170:171], v6 offset:50176
  v_add_f32 v63, v63, v95
  v_mul_f32 v16, v32, v32
  v_mul_f32 v17, v33, v33
  v_mul_f32 v18, v34, v34
  s_waitcnt lgkmcnt(6)
  v_mfma_f32_32x32x16_bf16 v[144:159], v[188:191], v[212:215], v[144:159]
  ds_read_b64_tr_b16 v[172:173], v7 offset:49152
  ds_read_b64_tr_b16 v[174:175], v7 offset:50176
  v_mul_f32 v19, v35, v35
  v_mul_f32 v20, v36, v36
  v_mul_f32 v21, v37, v37
  v_mul_f32 v22, v38, v38
  s_waitcnt lgkmcnt(6)
  v_mfma_f32_32x32x16_bf16 v[96:111], v[160:163], v[216:219], v[96:111]
  ds_read_b64_tr_b16 v[176:177], v4 offset:51200
  ds_read_b64_tr_b16 v[178:179], v4 offset:52224
  v_mul_f32 v23, v39, v39
  v_fma_f32 v16, v16, s73, v14
  v_fma_f32 v17, v17, s73, v14
  v_fma_f32 v18, v18, s73, v14
  s_waitcnt lgkmcnt(6)
  v_mfma_f32_32x32x16_bf16 v[112:127], v[164:167], v[216:219], v[112:127]
  ds_read_b64_tr_b16 v[180:181], v5 offset:51200
  ds_read_b64_tr_b16 v[182:183], v5 offset:52224
  v_fma_f32 v19, v19, s73, v14
  v_fma_f32 v20, v20, s73, v14
  v_fma_f32 v21, v21, s73, v14
  v_fma_f32 v22, v22, s73, v14
  s_waitcnt lgkmcnt(6)
  v_mfma_f32_32x32x16_bf16 v[128:143], v[168:171], v[216:219], v[128:143]
  ds_read_b64_tr_b16 v[184:185], v6 offset:51200
  ds_read_b64_tr_b16 v[186:187], v6 offset:52224
  v_fma_f32 v23, v23, s73, v14
  v_mul_f32 v16, v32, v16
  v_mul_f32 v17, v33, v17
  v_mul_f32 v18, v34, v18
  s_waitcnt lgkmcnt(6)
  v_mfma_f32_32x32x16_bf16 v[144:159], v[172:175], v[216:219], v[144:159]
  ds_read_b64_tr_b16 v[188:189], v7 offset:51200
  ds_read_b64_tr_b16 v[190:191], v7 offset:52224
  v_mul_f32 v19, v35, v19
  v_mul_f32 v20, v36, v20
  v_mul_f32 v21, v37, v21
  v_mul_f32 v22, v38, v22
  s_waitcnt lgkmcnt(6)
  v_mfma_f32_32x32x16_bf16 v[96:111], v[176:179], v[220:223], v[96:111]
  s_waitcnt vmcnt(2)
  s_barrier
  ds_read_b64_tr_b16 v[160:161], v8 offset:0
  ds_read_b64_tr_b16 v[162:163], v8 offset:1024
  v_mul_f32 v23, v39, v23
  v_exp_f32 v16, v16
  v_mul_f32 v40, v32, v40
  v_exp_f32 v17, v17
  s_waitcnt lgkmcnt(6)
  v_mfma_f32_32x32x16_bf16 v[112:127], v[180:183], v[220:223], v[112:127]
  s_add_u32 s76, s75, 7
  s_and_b32 s76, s76, 7
  s_mul_i32 s76, s76, 114688
  s_add_u32 s76, s76, s66
  s_add_u32 s76, s76, 128
  s_add_u32 m0, s67, 16384
  s_nop 0
  buffer_load_dwordx4 v3, s[40:43], s76 offen lds
  s_add_u32 s76, s76, 28672
  s_add_u32 m0, s67, 17408
  s_nop 0
  buffer_load_dwordx4 v3, s[40:43], s76 offen lds
  ds_read_b64_tr_b16 v[164:165], v9 offset:0
  ds_read_b64_tr_b16 v[166:167], v9 offset:1024
  v_mul_f32 v41, v33, v41
  v_exp_f32 v18, v18
  v_mul_f32 v42, v34, v42
  v_exp_f32 v19, v19
  s_waitcnt lgkmcnt(6)
  v_mfma_f32_32x32x16_bf16 v[128:143], v[184:187], v[220:223], v[128:143]
  ds_read_b64_tr_b16 v[168:169], v10 offset:0
  ds_read_b64_tr_b16 v[170:171], v10 offset:1024
  v_mul_f32 v43, v35, v43
  v_exp_f32 v20, v20
  v_mul_f32 v44, v36, v44
  v_exp_f32 v21, v21
  s_waitcnt lgkmcnt(6)
  v_mfma_f32_32x32x16_bf16 v[144:159], v[188:191], v[220:223], v[144:159]
  ds_read_b64_tr_b16 v[172:173], v11 offset:0
  ds_read_b64_tr_b16 v[174:175], v11 offset:1024
  v_mul_f32 v45, v37, v45
  v_exp_f32 v22, v22
  v_mul_f32 v46, v38, v46
  v_exp_f32 v23, v23
  s_waitcnt lgkmcnt(6)
  v_mfma_f32_32x32x16_bf16 v[96:111], v[160:163], v[224:227], v[96:111]
  ds_read_b64_tr_b16 v[176:177], v8 offset:2048
  ds_read_b64_tr_b16 v[178:179], v8 offset:3072
  v_mul_f32 v47, v39, v47
  v_add_f32 v16, 1.0, v16
  v_add_f32 v17, 1.0, v17
  v_add_f32 v18, 1.0, v18
  s_waitcnt lgkmcnt(6)
  v_mfma_f32_32x32x16_bf16 v[112:127], v[164:167], v[224:227], v[112:127]
  ds_read_b64_tr_b16 v[180:181], v9 offset:2048
  ds_read_b64_tr_b16 v[182:183], v9 offset:3072
  v_add_f32 v19, 1.0, v19
  v_add_f32 v20, 1.0, v20
  v_add_f32 v21, 1.0, v21
  v_add_f32 v22, 1.0, v22
  s_waitcnt lgkmcnt(6)
  v_mfma_f32_32x32x16_bf16 v[128:143], v[168:171], v[224:227], v[128:143]
  ds_read_b64_tr_b16 v[184:185], v10 offset:2048
  ds_read_b64_tr_b16 v[186:187], v10 offset:3072
  v_add_f32 v23, 1.0, v23
  v_rcp_f32 v16, v16
  v_rcp_f32 v17, v17
  v_rcp_f32 v18, v18
  s_waitcnt lgkmcnt(6)
  v_mfma_f32_32x32x16_bf16 v[144:159], v[172:175], v[224:227], v[144:159]
  ds_read_b64_tr_b16 v[188:189], v11 offset:2048
  ds_read_b64_tr_b16 v[190:191], v11 offset:3072
  v_rcp_f32 v19, v19
  v_rcp_f32 v20, v20
  v_rcp_f32 v21, v21
  v_rcp_f32 v22, v22
  s_waitcnt lgkmcnt(6)
  v_mfma_f32_32x32x16_bf16 v[96:111], v[176:179], v[228:231], v[96:111]
  ds_read_b64_tr_b16 v[160:161], v8 offset:16384
  ds_read_b64_tr_b16 v[162:163], v8 offset:17408
  v_rcp_f32 v23, v23
  v_mul_f32 v16, v40, v16
  v_mul_f32 v17, v41, v17
  v_mul_f32 v18, v42, v18
  s_waitcnt lgkmcnt(6)
  v_mfma_f32_32x32x16_bf16 v[112:127], v[180:183], v[228:231], v[112:127]
  s_mov_b32 s52, s28
  s_and_b32 s53, s29, 0xffff
  s_mov_b32 s54, 0x1c0000
  s_mov_b32 s55, 0x20000
  v_lshrrev_b32 v28, 2, v1
  v_lshlrev_b32 v28, 10, v28
  v_and_b32 v29, 3, v1
  v_lshlrev_b32 v29, 7, v29
  v_add_u32 v28, v28, v29
  s_lshl_b32 s78, s39, 2
  s_add_u32 s78, s78, s57
  s_mul_i32 s78, s78, 14336
  s_lshl_b32 s79, s38, 9
  s_add_u32 s78, s78, s79
  buffer_load_dword v31, v28, s[52:55], s78 offen
  ds_read_b64_tr_b16 v[164:165], v9 offset:16384
  ds_read_b64_tr_b16 v[166:167], v9 offset:17408
  v_mul_f32 v19, v43, v19
  v_mul_f32 v20, v44, v20
  v_mul_f32 v21, v45, v21
  v_mul_f32 v22, v46, v22
  s_waitcnt lgkmcnt(6)
  v_mfma_f32_32x32x16_bf16 v[128:143], v[184:187], v[228:231], v[128:143]
  ds_read_b64_tr_b16 v[168:169], v10 offset:16384
  ds_read_b64_tr_b16 v[170:171], v10 offset:17408
  v_mul_f32 v23, v47, v23
  v_cvt_pk_bf16_f32 v24, v16, v17
  v_cvt_pk_bf16_f32 v25, v18, v19
  v_cvt_pk_bf16_f32 v26, v20, v21
  s_waitcnt lgkmcnt(6)
  v_mfma_f32_32x32x16_bf16 v[144:159], v[188:191], v[228:231], v[144:159]
  ds_read_b64_tr_b16 v[172:173], v11 offset:16384
  ds_read_b64_tr_b16 v[174:175], v11 offset:17408
  v_cvt_pk_bf16_f32 v27, v22, v23
  s_add_u32 s64, s74, 0
  buffer_store_dwordx4 v[24:27], v2, s[48:51], s64 offen sc1
  v_mul_f32 v16, v48, v48
  s_waitcnt lgkmcnt(6)
  v_mfma_f32_32x32x16_bf16 v[96:111], v[160:163], v[232:235], v[96:111]
  ds_read_b64_tr_b16 v[176:177], v8 offset:18432
  ds_read_b64_tr_b16 v[178:179], v8 offset:19456
  v_mul_f32 v17, v49, v49
  v_mul_f32 v18, v50, v50
  v_mul_f32 v19, v51, v51
  v_mul_f32 v20, v52, v52
  s_waitcnt lgkmcnt(6)
  v_mfma_f32_32x32x16_bf16 v[112:127], v[164:167], v[232:235], v[112:127]
  ds_read_b64_tr_b16 v[180:181], v9 offset:18432
  ds_read_b64_tr_b16 v[182:183], v9 offset:19456
  v_mul_f32 v21, v53, v53
  v_mul_f32 v22, v54, v54
  v_mul_f32 v23, v55, v55
  v_fma_f32 v16, v16, s73, v14
  s_waitcnt lgkmcnt(6)
  v_mfma_f32_32x32x16_bf16 v[128:143], v[168:171], v[232:235], v[128:143]
  ds_read_b64_tr_b16 v[184:185], v10 offset:18432
  ds_read_b64_tr_b16 v[186:187], v10 offset:19456
  v_fma_f32 v17, v17, s73, v14
  v_fma_f32 v18, v18, s73, v14
  v_fma_f32 v19, v19, s73, v14
  v_fma_f32 v20, v20, s73, v14
  s_waitcnt lgkmcnt(6)
  v_mfma_f32_32x32x16_bf16 v[144:159], v[172:175], v[232:235], v[144:159]
  ds_read_b64_tr_b16 v[188:189], v11 offset:18432
  ds_read_b64_tr_b16 v[190:191], v11 offset:19456
  v_fma_f32 v21, v21, s73, v14
  v_fma_f32 v22, v22, s73, v14
  v_fma_f32 v23, v23, s73, v14
  v_mul_f32 v16, v48, v16
  s_waitcnt lgkmcnt(6)
  v_mfma_f32_32x32x16_bf16 v[96:111], v[176:179], v[236:239], v[96:111]
  s_waitcnt vmcnt(2)
  s_barrier
  ds_read_b64_tr_b16 v[160:161], v4 offset:0
  ds_read_b64_tr_b16 v[162:163], v4 offset:1024
  v_mul_f32 v17, v49, v17
  v_mul_f32 v18, v50, v18
  v_mul_f32 v19, v51, v19
  v_mul_f32 v20, v52, v20
  s_waitcnt lgkmcnt(6)
  v_mfma_f32_32x32x16_bf16 v[112:127], v[180:183], v[236:239], v[112:127]
  ds_read_b64_tr_b16 v[164:165], v5 offset:0
  ds_read_b64_tr_b16 v[166:167], v5 offset:1024
  v_mul_f32 v21, v53, v21
  v_mul_f32 v22, v54, v22
  v_mul_f32 v23, v55, v23
  v_exp_f32 v16, v16
  s_waitcnt lgkmcnt(6)
  v_mfma_f32_32x32x16_bf16 v[128:143], v[184:187], v[236:239], v[128:143]
  ds_read_b64_tr_b16 v[168:169], v6 offset:0
  ds_read_b64_tr_b16 v[170:171], v6 offset:1024
  v_mul_f32 v56, v48, v56
  v_exp_f32 v17, v17
  v_mul_f32 v57, v49, v57
  v_exp_f32 v18, v18
  s_waitcnt lgkmcnt(6)
  v_mfma_f32_32x32x16_bf16 v[144:159], v[188:191], v[236:239], v[144:159]
  ds_read_b64_tr_b16 v[172:173], v7 offset:0
  ds_read_b64_tr_b16 v[174:175], v7 offset:1024
  v_mul_f32 v58, v50, v58
  v_exp_f32 v19, v19
  v_mul_f32 v59, v51, v59
  v_exp_f32 v20, v20
  s_waitcnt lgkmcnt(6)
  v_mfma_f32_32x32x16_bf16 v[96:111], v[160:163], v[240:243], v[96:111]
  ds_read_b64_tr_b16 v[176:177], v4 offset:2048
  ds_read_b64_tr_b16 v[178:179], v4 offset:3072
  v_mul_f32 v60, v52, v60
  v_exp_f32 v21, v21
  v_mul_f32 v61, v53, v61
  v_exp_f32 v22, v22
  s_waitcnt lgkmcnt(6)
  v_mfma_f32_32x32x16_bf16 v[112:127], v[164:167], v[240:243], v[112:127]
  ds_read_b64_tr_b16 v[180:181], v5 offset:2048
  ds_read_b64_tr_b16 v[182:183], v5 offset:3072
  v_mul_f32 v62, v54, v62
  v_exp_f32 v23, v23
  v_mul_f32 v63, v55, v63
  v_add_f32 v16, 1.0, v16
  s_waitcnt lgkmcnt(6)
  v_mfma_f32_32x32x16_bf16 v[128:143], v[168:171], v[240:243], v[128:143]
  ds_read_b64_tr_b16 v[184:185], v6 offset:2048
  ds_read_b64_tr_b16 v[186:187], v6 offset:3072
  v_add_f32 v17, 1.0, v17
  v_add_f32 v18, 1.0, v18
  v_add_f32 v19, 1.0, v19
  v_add_f32 v20, 1.0, v20
  s_waitcnt lgkmcnt(6)
  v_mfma_f32_32x32x16_bf16 v[144:159], v[172:175], v[240:243], v[144:159]
  ds_read_b64_tr_b16 v[188:189], v7 offset:2048
  ds_read_b64_tr_b16 v[190:191], v7 offset:3072
  v_add_f32 v21, 1.0, v21
  v_add_f32 v22, 1.0, v22
  v_add_f32 v23, 1.0, v23
  v_rcp_f32 v16, v16
  s_waitcnt lgkmcnt(6)
  v_mfma_f32_32x32x16_bf16 v[96:111], v[176:179], v[244:247], v[96:111]
  ds_read_b64_tr_b16 v[160:161], v6 offset:16384
  ds_read_b64_tr_b16 v[162:163], v6 offset:17408
  v_rcp_f32 v17, v17
  v_rcp_f32 v18, v18
  v_rcp_f32 v19, v19
  v_rcp_f32 v20, v20
  s_waitcnt lgkmcnt(6)
  v_mfma_f32_32x32x16_bf16 v[112:127], v[180:183], v[244:247], v[112:127]
  ds_read_b64_tr_b16 v[164:165], v6 offset:18432
  ds_read_b64_tr_b16 v[166:167], v6 offset:19456
  v_rcp_f32 v21, v21
  v_rcp_f32 v22, v22
  v_rcp_f32 v23, v23
  v_mul_f32 v16, v56, v16
  s_waitcnt lgkmcnt(6)
  v_mfma_f32_32x32x16_bf16 v[128:143], v[184:187], v[244:247], v[128:143]
  ds_read_b64_tr_b16 v[168:169], v7 offset:16384
  ds_read_b64_tr_b16 v[170:171], v7 offset:17408
  v_mul_f32 v17, v57, v17
  v_mul_f32 v18, v58, v18
  v_mul_f32 v19, v59, v19
  v_mul_f32 v20, v60, v20
  s_waitcnt lgkmcnt(6)
  v_mfma_f32_32x32x16_bf16 v[144:159], v[188:191], v[244:247], v[144:159]
  ds_read_b64_tr_b16 v[172:173], v7 offset:18432
  ds_read_b64_tr_b16 v[174:175], v7 offset:19456
  v_mul_f32 v21, v61, v21
  v_mul_f32 v22, v62, v22
  v_mul_f32 v23, v63, v23
  v_cvt_pk_bf16_f32 v24, v16, v17
  s_waitcnt lgkmcnt(6)
  v_mfma_f32_32x32x16_bf16 v[128:143], v[160:163], v[248:251], v[128:143]
  ds_read_b64_tr_b16 v[176:177], v4 offset:16384
  ds_read_b64_tr_b16 v[178:179], v4 offset:17408
  v_cvt_pk_bf16_f32 v25, v18, v19
  v_cvt_pk_bf16_f32 v26, v20, v21
  v_cvt_pk_bf16_f32 v27, v22, v23
  s_add_u32 s64, s74, 1024
  s_waitcnt lgkmcnt(6)
  v_mfma_f32_32x32x16_bf16 v[128:143], v[164:167], v[252:255], v[128:143]
  ds_read_b64_tr_b16 v[180:181], v5 offset:16384
  ds_read_b64_tr_b16 v[182:183], v5 offset:17408
  buffer_store_dwordx4 v[24:27], v2, s[48:51], s64 offen sc1
  s_waitcnt lgkmcnt(6)
  v_mfma_f32_32x32x16_bf16 v[144:159], v[168:171], v[248:251], v[144:159]
  ds_read_b64_tr_b16 v[184:185], v4 offset:18432
  ds_read_b64_tr_b16 v[186:187], v4 offset:19456
  s_waitcnt lgkmcnt(6)
  v_mfma_f32_32x32x16_bf16 v[144:159], v[172:175], v[252:255], v[144:159]
  ds_read_b64_tr_b16 v[188:189], v5 offset:18432
  ds_read_b64_tr_b16 v[190:191], v5 offset:19456
  s_waitcnt lgkmcnt(6)
  v_mfma_f32_32x32x16_bf16 v[96:111], v[176:179], v[248:251], v[96:111]
  s_waitcnt lgkmcnt(4)
  v_mfma_f32_32x32x16_bf16 v[112:127], v[180:183], v[248:251], v[112:127]
  ds_write_b128 v12, v[128:131] offset:0
  ds_write_b128 v12, v[132:135] offset:1024
  s_waitcnt lgkmcnt(4)
  v_mfma_f32_32x32x16_bf16 v[96:111], v[184:187], v[252:255], v[96:111]
  ds_write_b128 v12, v[136:139] offset:2048
  ds_write_b128 v12, v[140:143] offset:3072
  s_waitcnt lgkmcnt(4)
  v_mfma_f32_32x32x16_bf16 v[112:127], v[188:191], v[252:255], v[112:127]
  ds_write_b128 v12, v[144:147] offset:4096
  ds_write_b128 v12, v[148:151] offset:5120
  ds_write_b128 v12, v[152:155] offset:6144
  ds_write_b128 v12, v[156:159] offset:7168
  s_waitcnt lgkmcnt(0)
  s_barrier
  ds_read_b128 v[128:131], v13 offset:0
  ds_read_b128 v[132:135], v13 offset:1024
  ds_read_b128 v[136:139], v13 offset:2048
  ds_read_b128 v[140:143], v13 offset:3072
  ds_read_b128 v[144:147], v13 offset:4096
  ds_read_b128 v[148:151], v13 offset:5120
  ds_read_b128 v[152:155], v13 offset:6144
  ds_read_b128 v[156:159], v13 offset:7168
  s_mov_b32 s44, s28
  s_and_b32 s45, s29, 0xffff
  s_mov_b32 s46, 0x1c0000
  s_mov_b32 s47, 0x20000
  s_and_b32 s79, s39, 7
  s_lshl_b32 s58, s37, 3
  s_add_u32 s58, s58, s79
  s_lshr_b32 s79, s39, 3
  s_lshl_b32 s59, s38, 2
  s_add_u32 s59, s59, s79
  s_lshl_b32 s58, s59, 7
  v_lshrrev_b32 v4, 3, v1
  v_and_b32 v5, 7, v1
  v_lshlrev_b32 v6, 1, v4
  v_and_b32 v6, 4, v6
  v_xor_b32 v5, v5, v6
  v_lshlrev_b32 v5, 4, v5
  s_mov_b32 s79, 1024
  v_mul_lo_u32 v30, v4, s79
  v_add_u32 v30, v30, v5
  s_and_b32 s76, s36, 1
  s_lshr_b32 s78, s36, 1
  s_mul_i32 s78, s78, 6
  s_mul_i32 s59, s76, 917504
  s_add_u32 s59, s59, s58
  s_lshl_b32 s77, s78, 14
  s_add_u32 s59, s59, s77
  s_lshl_b32 s77, s76, 11
  s_lshl_b32 s78, s78, 12
  s_add_u32 s77, s77, s78
  s_add_u32 s79, s59, 0
  s_mov_b32 m0, s77
  s_nop 0
  buffer_load_dwordx4 v30, s[44:47], s79 offen lds
  s_add_u32 s79, s59, 8192
  s_add_u32 m0, s77, 1024
  s_nop 0
  buffer_load_dwordx4 v30, s[44:47], s79 offen lds
  s_add_u32 s79, s59, 16384
  s_add_u32 m0, s77, 4096
  s_nop 0
  buffer_load_dwordx4 v30, s[44:47], s79 offen lds
  s_add_u32 s79, s59, 24576
  s_add_u32 m0, s77, 5120
  s_nop 0
  buffer_load_dwordx4 v30, s[44:47], s79 offen lds
  s_add_u32 s79, s59, 32768
  s_add_u32 m0, s77, 8192
  s_nop 0
  buffer_load_dwordx4 v30, s[44:47], s79 offen lds
  s_add_u32 s79, s59, 40960
  s_add_u32 m0, s77, 9216
  s_nop 0
  buffer_load_dwordx4 v30, s[44:47], s79 offen lds
  s_add_u32 s79, s59, 49152
  s_add_u32 m0, s77, 12288
  s_nop 0
  buffer_load_dwordx4 v30, s[44:47], s79 offen lds
  s_add_u32 s79, s59, 57344
  s_add_u32 m0, s77, 13312
  s_nop 0
  buffer_load_dwordx4 v30, s[44:47], s79 offen lds
  s_add_u32 s79, s59, 65536
  s_add_u32 m0, s77, 16384
  s_nop 0
  buffer_load_dwordx4 v30, s[44:47], s79 offen lds
  s_add_u32 s79, s59, 73728
  s_add_u32 m0, s77, 17408
  s_nop 0
  buffer_load_dwordx4 v30, s[44:47], s79 offen lds
  s_add_u32 s79, s59, 81920
  s_add_u32 m0, s77, 20480
  s_nop 0
  buffer_load_dwordx4 v30, s[44:47], s79 offen lds
  s_add_u32 s79, s59, 90112
  s_add_u32 m0, s77, 21504
  s_nop 0
  buffer_load_dwordx4 v30, s[44:47], s79 offen lds
  s_waitcnt lgkmcnt(0)
  v_pk_add_f32 v[96:97], v[96:97], v[128:129]
  v_pk_add_f32 v[98:99], v[98:99], v[130:131]
  v_pk_add_f32 v[100:101], v[100:101], v[132:133]
  v_pk_add_f32 v[102:103], v[102:103], v[134:135]
  v_pk_add_f32 v[104:105], v[104:105], v[136:137]
  v_pk_add_f32 v[106:107], v[106:107], v[138:139]
  v_pk_add_f32 v[108:109], v[108:109], v[140:141]
  v_pk_add_f32 v[110:111], v[110:111], v[142:143]
  v_pk_add_f32 v[112:113], v[112:113], v[144:145]
  v_pk_add_f32 v[114:115], v[114:115], v[146:147]
  v_pk_add_f32 v[116:117], v[116:117], v[148:149]
  v_pk_add_f32 v[118:119], v[118:119], v[150:151]
  v_pk_add_f32 v[120:121], v[120:121], v[152:153]
  v_pk_add_f32 v[122:123], v[122:123], v[154:155]
  v_pk_add_f32 v[124:125], v[124:125], v[156:157]
  v_pk_add_f32 v[126:127], v[126:127], v[158:159]
  v_pk_mul_f32 v[16:17], v[96:97], v[96:97]
  v_pk_mul_f32 v[18:19], v[98:99], v[98:99]
  v_pk_mul_f32 v[20:21], v[100:101], v[100:101]
  v_pk_mul_f32 v[22:23], v[102:103], v[102:103]
  v_pk_fma_f32 v[16:17], v[16:17], s[72:73], v[14:15] op_sel:[0,1,0] op_sel_hi:[1,1,0]
  v_pk_fma_f32 v[18:19], v[18:19], s[72:73], v[14:15] op_sel:[0,1,0] op_sel_hi:[1,1,0]
  v_pk_fma_f32 v[20:21], v[20:21], s[72:73], v[14:15] op_sel:[0,1,0] op_sel_hi:[1,1,0]
  v_pk_fma_f32 v[22:23], v[22:23], s[72:73], v[14:15] op_sel:[0,1,0] op_sel_hi:[1,1,0]
  v_pk_mul_f32 v[16:17], v[96:97], v[16:17]
  v_pk_mul_f32 v[18:19], v[98:99], v[18:19]
  v_pk_mul_f32 v[20:21], v[100:101], v[20:21]
  v_pk_mul_f32 v[22:23], v[102:103], v[22:23]
  v_exp_f32 v16, v16
  v_exp_f32 v17, v17
  v_pk_mul_f32 v[104:105], v[96:97], v[104:105]
  v_exp_f32 v18, v18
  v_exp_f32 v19, v19
  v_pk_mul_f32 v[106:107], v[98:99], v[106:107]
  v_exp_f32 v20, v20
  v_exp_f32 v21, v21
  v_pk_mul_f32 v[108:109], v[100:101], v[108:109]
  v_exp_f32 v22, v22
  v_exp_f32 v23, v23
  v_pk_mul_f32 v[110:111], v[102:103], v[110:111]
  v_pk_add_f32 v[16:17], v[16:17], 1.0 op_sel_hi:[1,0]
  v_pk_add_f32 v[18:19], v[18:19], 1.0 op_sel_hi:[1,0]
  v_pk_add_f32 v[20:21], v[20:21], 1.0 op_sel_hi:[1,0]
  v_pk_add_f32 v[22:23], v[22:23], 1.0 op_sel_hi:[1,0]
  v_rcp_f32 v16, v16
  v_rcp_f32 v17, v17
  v_rcp_f32 v18, v18
  v_rcp_f32 v19, v19
  v_rcp_f32 v20, v20
  v_rcp_f32 v21, v21
  v_rcp_f32 v22, v22
  v_rcp_f32 v23, v23
  v_pk_mul_f32 v[16:17], v[104:105], v[16:17]
  v_pk_mul_f32 v[18:19], v[106:107], v[18:19]
  v_pk_mul_f32 v[20:21], v[108:109], v[20:21]
  v_pk_mul_f32 v[22:23], v[110:111], v[22:23]
  v_cvt_pk_bf16_f32 v24, v16, v17
  v_cvt_pk_bf16_f32 v25, v18, v19
  v_cvt_pk_bf16_f32 v26, v20, v21
  v_cvt_pk_bf16_f32 v27, v22, v23
  s_add_u32 s64, s74, 4096
  buffer_store_dwordx4 v[24:27], v2, s[48:51], s64 offen sc1
  v_pk_mul_f32 v[16:17], v[112:113], v[112:113]
  v_pk_mul_f32 v[18:19], v[114:115], v[114:115]
  v_pk_mul_f32 v[20:21], v[116:117], v[116:117]
  v_pk_mul_f32 v[22:23], v[118:119], v[118:119]
  v_pk_fma_f32 v[16:17], v[16:17], s[72:73], v[14:15] op_sel:[0,1,0] op_sel_hi:[1,1,0]
  v_pk_fma_f32 v[18:19], v[18:19], s[72:73], v[14:15] op_sel:[0,1,0] op_sel_hi:[1,1,0]
  v_pk_fma_f32 v[20:21], v[20:21], s[72:73], v[14:15] op_sel:[0,1,0] op_sel_hi:[1,1,0]
  v_pk_fma_f32 v[22:23], v[22:23], s[72:73], v[14:15] op_sel:[0,1,0] op_sel_hi:[1,1,0]
  v_pk_mul_f32 v[16:17], v[112:113], v[16:17]
  v_pk_mul_f32 v[18:19], v[114:115], v[18:19]
  v_pk_mul_f32 v[20:21], v[116:117], v[20:21]
  v_pk_mul_f32 v[22:23], v[118:119], v[22:23]
  v_exp_f32 v16, v16
  v_exp_f32 v17, v17
  v_pk_mul_f32 v[120:121], v[112:113], v[120:121]
  v_exp_f32 v18, v18
  v_exp_f32 v19, v19
  v_pk_mul_f32 v[122:123], v[114:115], v[122:123]
  v_exp_f32 v20, v20
  v_exp_f32 v21, v21
  v_pk_mul_f32 v[124:125], v[116:117], v[124:125]
  v_exp_f32 v22, v22
  v_exp_f32 v23, v23
  v_pk_mul_f32 v[126:127], v[118:119], v[126:127]
  v_pk_add_f32 v[16:17], v[16:17], 1.0 op_sel_hi:[1,0]
  v_pk_add_f32 v[18:19], v[18:19], 1.0 op_sel_hi:[1,0]
  v_pk_add_f32 v[20:21], v[20:21], 1.0 op_sel_hi:[1,0]
  v_pk_add_f32 v[22:23], v[22:23], 1.0 op_sel_hi:[1,0]
  v_rcp_f32 v16, v16
  v_rcp_f32 v17, v17
  v_rcp_f32 v18, v18
  v_rcp_f32 v19, v19
  v_rcp_f32 v20, v20
  v_rcp_f32 v21, v21
  v_rcp_f32 v22, v22
  v_rcp_f32 v23, v23
  v_pk_mul_f32 v[16:17], v[120:121], v[16:17]
  v_pk_mul_f32 v[18:19], v[122:123], v[18:19]
  v_pk_mul_f32 v[20:21], v[124:125], v[20:21]
  v_pk_mul_f32 v[22:23], v[126:127], v[22:23]
  v_cvt_pk_bf16_f32 v24, v16, v17
  v_cvt_pk_bf16_f32 v25, v18, v19
  v_cvt_pk_bf16_f32 v26, v20, v21
  v_cvt_pk_bf16_f32 v27, v22, v23
  s_add_u32 s64, s74, 5120
  buffer_store_dwordx4 v[24:27], v2, s[48:51], s64 offen sc1
  s_nop 1
  s_branch L_p4_done
L_p4_idle:
  s_mov_b32 s44, s28
  s_and_b32 s45, s29, 0xffff
  s_mov_b32 s46, 0x1c0000
  s_mov_b32 s47, 0x20000
  s_and_b32 s79, s39, 7
  s_lshl_b32 s58, s37, 3
  s_add_u32 s58, s58, s79
  s_lshr_b32 s79, s39, 3
  s_lshl_b32 s59, s38, 2
  s_add_u32 s59, s59, s79
  s_lshl_b32 s58, s59, 7
  v_lshrrev_b32 v4, 3, v1
  v_and_b32 v5, 7, v1
  v_lshlrev_b32 v6, 1, v4
  v_and_b32 v6, 4, v6
  v_xor_b32 v5, v5, v6
  v_lshlrev_b32 v5, 4, v5
  s_mov_b32 s79, 1024
  v_mul_lo_u32 v30, v4, s79
  v_add_u32 v30, v30, v5
  s_and_b32 s76, s36, 1
  s_lshr_b32 s78, s36, 1
  s_mul_i32 s78, s78, 6
  s_mul_i32 s59, s76, 917504
  s_add_u32 s59, s59, s58
  s_lshl_b32 s77, s78, 14
  s_add_u32 s59, s59, s77
  s_lshl_b32 s77, s76, 11
  s_lshl_b32 s78, s78, 12
  s_add_u32 s77, s77, s78
  s_add_u32 s79, s59, 0
  s_mov_b32 m0, s77
  s_nop 0
  buffer_load_dwordx4 v30, s[44:47], s79 offen lds
  s_add_u32 s79, s59, 8192
  s_add_u32 m0, s77, 1024
  s_nop 0
  buffer_load_dwordx4 v30, s[44:47], s79 offen lds
  s_add_u32 s79, s59, 16384
  s_add_u32 m0, s77, 4096
  s_nop 0
  buffer_load_dwordx4 v30, s[44:47], s79 offen lds
  s_add_u32 s79, s59, 24576
  s_add_u32 m0, s77, 5120
  s_nop 0
  buffer_load_dwordx4 v30, s[44:47], s79 offen lds
  s_add_u32 s79, s59, 32768
  s_add_u32 m0, s77, 8192
  s_nop 0
  buffer_load_dwordx4 v30, s[44:47], s79 offen lds
  s_add_u32 s79, s59, 40960
  s_add_u32 m0, s77, 9216
  s_nop 0
  buffer_load_dwordx4 v30, s[44:47], s79 offen lds
  s_add_u32 s79, s59, 49152
  s_add_u32 m0, s77, 12288
  s_nop 0
  buffer_load_dwordx4 v30, s[44:47], s79 offen lds
  s_add_u32 s79, s59, 57344
  s_add_u32 m0, s77, 13312
  s_nop 0
  buffer_load_dwordx4 v30, s[44:47], s79 offen lds
  s_add_u32 s79, s59, 65536
  s_add_u32 m0, s77, 16384
  s_nop 0
  buffer_load_dwordx4 v30, s[44:47], s79 offen lds
  s_add_u32 s79, s59, 73728
  s_add_u32 m0, s77, 17408
  s_nop 0
  buffer_load_dwordx4 v30, s[44:47], s79 offen lds
  s_add_u32 s79, s59, 81920
  s_add_u32 m0, s77, 20480
  s_nop 0
  buffer_load_dwordx4 v30, s[44:47], s79 offen lds
  s_add_u32 s79, s59, 90112
  s_add_u32 m0, s77, 21504
  s_nop 0
  buffer_load_dwordx4 v30, s[44:47], s79 offen lds
L_p4_done:
  s_waitcnt vmcnt(0)
  s_barrier
  s_and_b32 s64, s39, 3
  s_lshl_b32 s62, s37, 2
  s_add_u32 s62, s62, s64
  s_lshr_b32 s64, s39, 2
  s_mul_i32 s63, s38, 7
  s_add_u32 s63, s63, s64
  s_cmp_eq_u32 s64, 7
  s_cbranch_scc1 L_p4_nosig
  s_mov_b32 s70, s62
  s_lshr_b32 s71, s39, 2
  s_mul_i32 s72, s38, 7
  s_add_u32 s71, s71, s72
  s_cmp_lg_u32 s36, 0
  s_cbranch_scc1 L_sig3
  s_lshl_b32 s78, s70, 11
  s_add_u32 s78, s78, 20316160
  s_lshl_b32 s79, s71, 6
  s_add_u32 s78, s78, s79
  v_mov_b32 v10, s56
  v_mov_b32 v11, 0
  s_mov_b64 exec, 1
  buffer_store_dword v10, v11, s[48:51], s78 offen sc1
  s_mov_b64 exec, -1
L_sig3:
L_p4_nosig:
  s_and_b32 s64, s39, 7
  s_lshl_b32 s62, s37, 3
  s_add_u32 s62, s62, s64
  s_lshr_b32 s64, s39, 3
  s_lshl_b32 s63, s38, 2
  s_add_u32 s63, s63, s64
  s_cmp_lt_u32 s36, 4
  s_cbranch_scc0 L_p5_helper
  s_and_b32 s66, s36, 1
  s_lshr_b32 s67, s36, 1
  s_lshl_b32 s64, s62, 1
  s_add_u32 s64, s64, s66
  s_mov_b32 s70, s64
  s_mul_i32 s68, s64, 114688
  s_mul_i32 s64, s67, 57344
  s_add_u32 s68, s68, s64
  s_add_u32 s68, s68, 12582912
  s_lshl_b32 s69, s70, 5
  s_lshl_b32 s64, s63, 2
  s_add_u32 s69, s69, s64
  s_lshl_b32 s64, s67, 1
  s_add_u32 s69, s69, s64
  s_lshl_b32 s69, s69, 10
  s_add_u32 s69, s69, 8388608
  s_xor_b32 s64, s67, 0
  v_and_b32 v4, 15, v1
  v_lshrrev_b32 v5, 2, v4
  v_lshrrev_b32 v6, 5, v1
  v_lshlrev_b32 v6, 2, v6
  v_add_u32 v5, v5, v6
  v_lshlrev_b32 v8, 7, v5
  v_lshrrev_b32 v5, 3, v4
  v_xor_b32 v5, s64, v5
  v_lshlrev_b32 v5, 6, v5
  v_add_u32 v8, v8, v5
  v_and_b32 v5, 16, v1
  v_lshlrev_b32 v5, 1, v5
  v_add_u32 v8, v8, v5
  v_and_b32 v5, 3, v4
  v_lshlrev_b32 v5, 3, v5
  v_add_u32 v8, v8, v5
  s_lshl_b32 s65, s67, 11
  v_add_u32 v8, s65, v8
  v_add_u32 v10, 0x10000, v8
  v_add_u32 v12, 0x20000, v8
  s_xor_b32 s64, s67, 1
  v_and_b32 v4, 15, v1
  v_lshrrev_b32 v5, 2, v4
  v_lshrrev_b32 v6, 5, v1
  v_lshlrev_b32 v6, 2, v6
  v_add_u32 v5, v5, v6
  v_lshlrev_b32 v9, 7, v5
  v_lshrrev_b32 v5, 3, v4
  v_xor_b32 v5, s64, v5
  v_lshlrev_b32 v5, 6, v5
  v_add_u32 v9, v9, v5
  v_and_b32 v5, 16, v1
  v_lshlrev_b32 v5, 1, v5
  v_add_u32 v9, v9, v5
  v_and_b32 v5, 3, v4
  v_lshlrev_b32 v5, 3, v5
  v_add_u32 v9, v9, v5
  s_lshl_b32 s65, s67, 11
  v_add_u32 v9, s65, v9
  v_add_u32 v11, 0x10000, v9
  v_add_u32 v13, 0x20000, v9
  v_and_b32 v4, 31, v1
  v_lshlrev_b32 v14, 10, v4
  v_lshrrev_b32 v4, 5, v1
  v_lshlrev_b32 v4, 4, v4
  v_add_u32 v14, v14, v4
  s_lshl_b32 s71, s70, 15
  s_lshl_b32 s64, s63, 7
  s_add_u32 s71, s71, s64
  s_lshl_b32 s64, s67, 6
  s_add_u32 s71, s71, s64
  s_lshl_b32 s64, s36, 12
  v_add_u32 v15, s64, v2
  s_xor_b32 s64, s36, 2
  s_lshl_b32 s64, s64, 12
  v_add_u32 v7, s64, v2
  s_mov_b32 s40, s30
  s_and_b32 s41, s31, 0xffff
  s_mov_b32 s42, 0x200000
  s_mov_b32 s43, 0x20000
  buffer_load_dwordx4 v[240:243], v2, s[48:51], s69 offen offset:0 sc1
  buffer_load_dwordx4 v[244:247], v2, s[48:51], s69 offen offset:1024 sc1
  s_lshr_b32 s72, s62, 1
  s_lshl_b32 s78, s72, 11
  s_add_u32 s78, s78, 20316160
  v_lshlrev_b32 v250, 6, v1
  s_mov_b32 exec_lo, 0x3fff
  s_mov_b32 exec_hi, 0
  s_mov_b32 s79, 0
  s_waitcnt vmcnt(0)
  buffer_load_dword v251, v250, s[48:51], s78 offen sc1
  s_sleep 3
  buffer_load_dword v252, v250, s[48:51], s78 offen sc1
L_wfp5_poll:
  s_waitcnt vmcnt(1)
  v_cmp_ne_u32 vcc, s56, v251
  s_cbranch_vccz L_wfp5_out
  buffer_load_dword v251, v250, s[48:51], s78 offen sc1
  s_waitcnt vmcnt(1)
  v_cmp_ne_u32 vcc, s56, v252
  s_cbranch_vccz L_wfp5_out
  buffer_load_dword v252, v250, s[48:51], s78 offen sc1
  s_add_u32 s79, s79, 1
  s_cmp_gt_u32 s79, 0x40000
  s_cbranch_scc0 L_wfp5_poll
L_wfp5_out:
  s_mov_b64 exec, -1
  s_add_u32 s73, s68, 0
  buffer_load_dwordx4 v[64:67], v2, s[48:51], s73 offen offset:0 sc1
  buffer_load_dwordx4 v[68:71], v2, s[48:51], s73 offen offset:1024 sc1
  buffer_load_dwordx4 v[72:75], v2, s[48:51], s73 offen offset:2048 sc1
  buffer_load_dwordx4 v[76:79], v2, s[48:51], s73 offen offset:3072 sc1
  s_add_u32 s73, s68, 4096
  buffer_load_dwordx4 v[80:83], v2, s[48:51], s73 offen offset:0 sc1
  buffer_load_dwordx4 v[84:87], v2, s[48:51], s73 offen offset:1024 sc1
  buffer_load_dwordx4 v[88:91], v2, s[48:51], s73 offen offset:2048 sc1
  buffer_load_dwordx4 v[92:95], v2, s[48:51], s73 offen offset:3072 sc1
  ds_read_b64_tr_b16 v[48:49], v8 offset:0
  ds_read_b64_tr_b16 v[50:51], v8 offset:1024
  ds_read_b64_tr_b16 v[52:53], v9 offset:0
  ds_read_b64_tr_b16 v[54:55], v9 offset:1024
  s_waitcnt vmcnt(7)
  s_waitcnt lgkmcnt(2)
  v_mfma_f32_32x32x16_bf16 v[16:31], v[48:51], v[64:67], 0
  ds_read_b64_tr_b16 v[56:57], v8 offset:4096
  ds_read_b64_tr_b16 v[58:59], v8 offset:5120
  s_add_u32 s73, s68, 8192
  buffer_load_dwordx4 v[96:99], v2, s[48:51], s73 offen offset:0 sc1
  s_waitcnt lgkmcnt(2)
  v_mfma_f32_32x32x16_bf16 v[32:47], v[52:55], v[64:67], 0
  ds_read_b64_tr_b16 v[60:61], v9 offset:4096
  ds_read_b64_tr_b16 v[62:63], v9 offset:5120
  s_waitcnt vmcnt(7)
  s_waitcnt lgkmcnt(2)
  v_mfma_f32_32x32x16_bf16 v[16:31], v[56:59], v[68:71], v[16:31]
  ds_read_b64_tr_b16 v[48:49], v8 offset:8192
  ds_read_b64_tr_b16 v[50:51], v8 offset:9216
  buffer_load_dwordx4 v[100:103], v2, s[48:51], s73 offen offset:1024 sc1
  s_waitcnt lgkmcnt(2)
  v_mfma_f32_32x32x16_bf16 v[32:47], v[60:63], v[68:71], v[32:47]
  ds_read_b64_tr_b16 v[52:53], v9 offset:8192
  ds_read_b64_tr_b16 v[54:55], v9 offset:9216
  s_waitcnt vmcnt(7)
  s_waitcnt lgkmcnt(2)
  v_mfma_f32_32x32x16_bf16 v[16:31], v[48:51], v[72:75], v[16:31]
  ds_read_b64_tr_b16 v[56:57], v8 offset:12288
  ds_read_b64_tr_b16 v[58:59], v8 offset:13312
  buffer_load_dwordx4 v[104:107], v2, s[48:51], s73 offen offset:2048 sc1
  s_waitcnt lgkmcnt(2)
  v_mfma_f32_32x32x16_bf16 v[32:47], v[52:55], v[72:75], v[32:47]
  ds_read_b64_tr_b16 v[60:61], v9 offset:12288
  ds_read_b64_tr_b16 v[62:63], v9 offset:13312
  s_waitcnt vmcnt(7)
  s_waitcnt lgkmcnt(2)
  v_mfma_f32_32x32x16_bf16 v[16:31], v[56:59], v[76:79], v[16:31]
  ds_read_b64_tr_b16 v[48:49], v8 offset:16384
  ds_read_b64_tr_b16 v[50:51], v8 offset:17408
  buffer_load_dwordx4 v[108:111], v2, s[48:51], s73 offen offset:3072 sc1
  s_waitcnt lgkmcnt(2)
  v_mfma_f32_32x32x16_bf16 v[32:47], v[60:63], v[76:79], v[32:47]
  ds_read_b64_tr_b16 v[52:53], v9 offset:16384
  ds_read_b64_tr_b16 v[54:55], v9 offset:17408
  s_waitcnt vmcnt(7)
  s_waitcnt lgkmcnt(2)
  v_mfma_f32_32x32x16_bf16 v[16:31], v[48:51], v[80:83], v[16:31]
  ds_read_b64_tr_b16 v[56:57], v8 offset:20480
  ds_read_b64_tr_b16 v[58:59], v8 offset:21504
  s_add_u32 s73, s68, 12288
  buffer_load_dwordx4 v[112:115], v2, s[48:51], s73 offen offset:0 sc1
  s_waitcnt lgkmcnt(2)
  v_mfma_f32_32x32x16_bf16 v[32:47], v[52:55], v[80:83], v[32:47]
  ds_read_b64_tr_b16 v[60:61], v9 offset:20480
  ds_read_b64_tr_b16 v[62:63], v9 offset:21504
  s_waitcnt vmcnt(7)
  s_waitcnt lgkmcnt(2)
  v_mfma_f32_32x32x16_bf16 v[16:31], v[56:59], v[84:87], v[16:31]
  ds_read_b64_tr_b16 v[48:49], v8 offset:24576
  ds_read_b64_tr_b16 v[50:51], v8 offset:25600
  buffer_load_dwordx4 v[116:119], v2, s[48:51], s73 offen offset:1024 sc1
  s_waitcnt lgkmcnt(2)
  v_mfma_f32_32x32x16_bf16 v[32:47], v[60:63], v[84:87], v[32:47]
  ds_read_b64_tr_b16 v[52:53], v9 offset:24576
  ds_read_b64_tr_b16 v[54:55], v9 offset:25600
  s_waitcnt vmcnt(7)
  s_waitcnt lgkmcnt(2)
  v_mfma_f32_32x32x16_bf16 v[16:31], v[48:51], v[88:91], v[16:31]
  ds_read_b64_tr_b16 v[56:57], v8 offset:28672
  ds_read_b64_tr_b16 v[58:59], v8 offset:29696
  buffer_load_dwordx4 v[120:123], v2, s[48:51], s73 offen offset:2048 sc1
  s_waitcnt lgkmcnt(2)
  v_mfma_f32_32x32x16_bf16 v[32:47], v[52:55], v[88:91], v[32:47]
  ds_read_b64_tr_b16 v[60:61], v9 offset:28672
  ds_read_b64_tr_b16 v[62:63], v9 offset:29696
  s_waitcnt vmcnt(7)
  s_waitcnt lgkmcnt(2)
  v_mfma_f32_32x32x16_bf16 v[16:31], v[56:59], v[92:95], v[16:31]
  ds_read_b64_tr_b16 v[48:49], v8 offset:32768
  ds_read_b64_tr_b16 v[50:51], v8 offset:33792
  buffer_load_dwordx4 v[124:127], v2, s[48:51], s73 offen offset:3072 sc1
  s_waitcnt lgkmcnt(2)
  v_mfma_f32_32x32x16_bf16 v[32:47], v[60:63], v[92:95], v[32:47]
  ds_read_b64_tr_b16 v[52:53], v9 offset:32768
  ds_read_b64_tr_b16 v[54:55], v9 offset:33792
  s_waitcnt vmcnt(7)
  s_waitcnt lgkmcnt(2)
  v_mfma_f32_32x32x16_bf16 v[16:31], v[48:51], v[96:99], v[16:31]
  ds_read_b64_tr_b16 v[56:57], v8 offset:36864
  ds_read_b64_tr_b16 v[58:59], v8 offset:37888
  s_add_u32 s73, s68, 16384
  buffer_load_dwordx4 v[64:67], v2, s[48:51], s73 offen offset:0 sc1
  s_waitcnt lgkmcnt(2)
  v_mfma_f32_32x32x16_bf16 v[32:47], v[52:55], v[96:99], v[32:47]
  ds_read_b64_tr_b16 v[60:61], v9 offset:36864
  ds_read_b64_tr_b16 v[62:63], v9 offset:37888
  s_waitcnt vmcnt(7)
  s_waitcnt lgkmcnt(2)
  v_mfma_f32_32x32x16_bf16 v[16:31], v[56:59], v[100:103], v[16:31]
  ds_read_b64_tr_b16 v[48:49], v8 offset:40960
  ds_read_b64_tr_b16 v[50:51], v8 offset:41984
  buffer_load_dwordx4 v[68:71], v2, s[48:51], s73 offen offset:1024 sc1
  s_waitcnt lgkmcnt(2)
  v_mfma_f32_32x32x16_bf16 v[32:47], v[60:63], v[100:103], v[32:47]
  ds_read_b64_tr_b16 v[52:53], v9 offset:40960
  ds_read_b64_tr_b16 v[54:55], v9 offset:41984
  s_waitcnt vmcnt(7)
  s_waitcnt lgkmcnt(2)
  v_mfma_f32_32x32x16_bf16 v[16:31], v[48:51], v[104:107], v[16:31]
  ds_read_b64_tr_b16 v[56:57], v8 offset:45056
  ds_read_b64_tr_b16 v[58:59], v8 offset:46080
  buffer_load_dwordx4 v[72:75], v2, s[48:51], s73 offen offset:2048 sc1
  s_waitcnt lgkmcnt(2)
  v_mfma_f32_32x32x16_bf16 v[32:47], v[52:55], v[104:107], v[32:47]
  ds_read_b64_tr_b16 v[60:61], v9 offset:45056
  ds_read_b64_tr_b16 v[62:63], v9 offset:46080
  s_waitcnt vmcnt(7)
  s_waitcnt lgkmcnt(2)
  v_mfma_f32_32x32x16_bf16 v[16:31], v[56:59], v[108:111], v[16:31]
  ds_read_b64_tr_b16 v[48:49], v8 offset:49152
  ds_read_b64_tr_b16 v[50:51], v8 offset:50176
  buffer_load_dwordx4 v[76:79], v2, s[48:51], s73 offen offset:3072 sc1
  s_waitcnt lgkmcnt(2)
  v_mfma_f32_32x32x16_bf16 v[32:47], v[60:63], v[108:111], v[32:47]
  ds_read_b64_tr_b16 v[52:53], v9 offset:49152
  ds_read_b64_tr_b16 v[54:55], v9 offset:50176
  s_waitcnt vmcnt(7)
  s_waitcnt lgkmcnt(2)
  v_mfma_f32_32x32x16_bf16 v[16:31], v[48:51], v[112:115], v[16:31]
  ds_read_b64_tr_b16 v[56:57], v8 offset:53248
  ds_read_b64_tr_b16 v[58:59], v8 offset:54272
  s_add_u32 s73, s68, 20480
  buffer_load_dwordx4 v[80:83], v2, s[48:51], s73 offen offset:0 sc1
  s_waitcnt lgkmcnt(2)
  v_mfma_f32_32x32x16_bf16 v[32:47], v[52:55], v[112:115], v[32:47]
  ds_read_b64_tr_b16 v[60:61], v9 offset:53248
  ds_read_b64_tr_b16 v[62:63], v9 offset:54272
  s_waitcnt vmcnt(7)
  s_waitcnt lgkmcnt(2)
  v_mfma_f32_32x32x16_bf16 v[16:31], v[56:59], v[116:119], v[16:31]
  ds_read_b64_tr_b16 v[48:49], v8 offset:57344
  ds_read_b64_tr_b16 v[50:51], v8 offset:58368
  buffer_load_dwordx4 v[84:87], v2, s[48:51], s73 offen offset:1024 sc1
  s_waitcnt lgkmcnt(2)
  v_mfma_f32_32x32x16_bf16 v[32:47], v[60:63], v[116:119], v[32:47]
  ds_read_b64_tr_b16 v[52:53], v9 offset:57344
  ds_read_b64_tr_b16 v[54:55], v9 offset:58368
  s_waitcnt vmcnt(7)
  s_waitcnt lgkmcnt(2)
  v_mfma_f32_32x32x16_bf16 v[16:31], v[48:51], v[120:123], v[16:31]
  ds_read_b64_tr_b16 v[56:57], v8 offset:61440
  ds_read_b64_tr_b16 v[58:59], v8 offset:62464
  buffer_load_dwordx4 v[88:91], v2, s[48:51], s73 offen offset:2048 sc1
  s_waitcnt lgkmcnt(2)
  v_mfma_f32_32x32x16_bf16 v[32:47], v[52:55], v[120:123], v[32:47]
  ds_read_b64_tr_b16 v[60:61], v9 offset:61440
  ds_read_b64_tr_b16 v[62:63], v9 offset:62464
  s_waitcnt vmcnt(7)
  s_waitcnt lgkmcnt(2)
  v_mfma_f32_32x32x16_bf16 v[16:31], v[56:59], v[124:127], v[16:31]
  ds_read_b64_tr_b16 v[48:49], v10 offset:0
  ds_read_b64_tr_b16 v[50:51], v10 offset:1024
  buffer_load_dwordx4 v[92:95], v2, s[48:51], s73 offen offset:3072 sc1
  s_waitcnt lgkmcnt(2)
  v_mfma_f32_32x32x16_bf16 v[32:47], v[60:63], v[124:127], v[32:47]
  ds_read_b64_tr_b16 v[52:53], v11 offset:0
  ds_read_b64_tr_b16 v[54:55], v11 offset:1024
  s_waitcnt vmcnt(7)
  s_waitcnt lgkmcnt(2)
  v_mfma_f32_32x32x16_bf16 v[16:31], v[48:51], v[64:67], v[16:31]
  ds_read_b64_tr_b16 v[56:57], v10 offset:4096
  ds_read_b64_tr_b16 v[58:59], v10 offset:5120
  s_add_u32 s73, s68, 24576
  buffer_load_dwordx4 v[96:99], v2, s[48:51], s73 offen offset:0 sc1
  s_waitcnt lgkmcnt(2)
  v_mfma_f32_32x32x16_bf16 v[32:47], v[52:55], v[64:67], v[32:47]
  ds_read_b64_tr_b16 v[60:61], v11 offset:4096
  ds_read_b64_tr_b16 v[62:63], v11 offset:5120
  s_waitcnt vmcnt(7)
  s_waitcnt lgkmcnt(2)
  v_mfma_f32_32x32x16_bf16 v[16:31], v[56:59], v[68:71], v[16:31]
  ds_read_b64_tr_b16 v[48:49], v10 offset:8192
  ds_read_b64_tr_b16 v[50:51], v10 offset:9216
  buffer_load_dwordx4 v[100:103], v2, s[48:51], s73 offen offset:1024 sc1
  s_waitcnt lgkmcnt(2)
  v_mfma_f32_32x32x16_bf16 v[32:47], v[60:63], v[68:71], v[32:47]
  ds_read_b64_tr_b16 v[52:53], v11 offset:8192
  ds_read_b64_tr_b16 v[54:55], v11 offset:9216
  s_barrier
  s_waitcnt vmcnt(7)
  s_waitcnt lgkmcnt(2)
  v_mfma_f32_32x32x16_bf16 v[16:31], v[48:51], v[72:75], v[16:31]
  ds_read_b64_tr_b16 v[56:57], v10 offset:12288
  ds_read_b64_tr_b16 v[58:59], v10 offset:13312
  buffer_load_dwordx4 v[104:107], v2, s[48:51], s73 offen offset:2048 sc1
  s_waitcnt lgkmcnt(2)
  v_mfma_f32_32x32x16_bf16 v[32:47], v[52:55], v[72:75], v[32:47]
  ds_read_b64_tr_b16 v[60:61], v11 offset:12288
  ds_read_b64_tr_b16 v[62:63], v11 offset:13312
  s_waitcnt vmcnt(7)
  s_waitcnt lgkmcnt(2)
  v_mfma_f32_32x32x16_bf16 v[16:31], v[56:59], v[76:79], v[16:31]
  ds_read_b64_tr_b16 v[48:49], v10 offset:16384
  ds_read_b64_tr_b16 v[50:51], v10 offset:17408
  buffer_load_dwordx4 v[108:111], v2, s[48:51], s73 offen offset:3072 sc1
  s_waitcnt lgkmcnt(2)
  v_mfma_f32_32x32x16_bf16 v[32:47], v[60:63], v[76:79], v[32:47]
  ds_read_b64_tr_b16 v[52:53], v11 offset:16384
  ds_read_b64_tr_b16 v[54:55], v11 offset:17408
  s_waitcnt vmcnt(7)
  s_waitcnt lgkmcnt(2)
  v_mfma_f32_32x32x16_bf16 v[16:31], v[48:51], v[80:83], v[16:31]
  ds_read_b64_tr_b16 v[56:57], v10 offset:20480
  ds_read_b64_tr_b16 v[58:59], v10 offset:21504
  s_add_u32 s73, s68, 28672
  buffer_load_dwordx4 v[112:115], v2, s[48:51], s73 offen offset:0 sc1
  s_waitcnt lgkmcnt(2)
  v_mfma_f32_32x32x16_bf16 v[32:47], v[52:55], v[80:83], v[32:47]
  ds_read_b64_tr_b16 v[60:61], v11 offset:20480
  ds_read_b64_tr_b16 v[62:63], v11 offset:21504
  s_waitcnt vmcnt(7)
  s_waitcnt lgkmcnt(2)
  v_mfma_f32_32x32x16_bf16 v[16:31], v[56:59], v[84:87], v[16:31]
  ds_read_b64_tr_b16 v[48:49], v10 offset:24576
  ds_read_b64_tr_b16 v[50:51], v10 offset:25600
  buffer_load_dwordx4 v[116:119], v2, s[48:51], s73 offen offset:1024 sc1
  s_waitcnt lgkmcnt(2)
  v_mfma_f32_32x32x16_bf16 v[32:47], v[60:63], v[84:87], v[32:47]
  ds_read_b64_tr_b16 v[52:53], v11 offset:24576
  ds_read_b64_tr_b16 v[54:55], v11 offset:25600
  s_waitcnt vmcnt(7)
  s_waitcnt lgkmcnt(2)
  v_mfma_f32_32x32x16_bf16 v[16:31], v[48:51], v[88:91], v[16:31]
  ds_read_b64_tr_b16 v[56:57], v10 offset:28672
  ds_read_b64_tr_b16 v[58:59], v10 offset:29696
  buffer_load_dwordx4 v[120:123], v2, s[48:51], s73 offen offset:2048 sc1
  s_waitcnt lgkmcnt(2)
  v_mfma_f32_32x32x16_bf16 v[32:47], v[52:55], v[88:91], v[32:47]
  ds_read_b64_tr_b16 v[60:61], v11 offset:28672
  ds_read_b64_tr_b16 v[62:63], v11 offset:29696
  s_waitcnt vmcnt(7)
  s_waitcnt lgkmcnt(2)
  v_mfma_f32_32x32x16_bf16 v[16:31], v[56:59], v[92:95], v[16:31]
  ds_read_b64_tr_b16 v[48:49], v10 offset:32768
  ds_read_b64_tr_b16 v[50:51], v10 offset:33792
  buffer_load_dwordx4 v[124:127], v2, s[48:51], s73 offen offset:3072 sc1
  s_waitcnt lgkmcnt(2)
  v_mfma_f32_32x32x16_bf16 v[32:47], v[60:63], v[92:95], v[32:47]
  ds_read_b64_tr_b16 v[52:53], v11 offset:32768
  ds_read_b64_tr_b16 v[54:55], v11 offset:33792
  s_waitcnt vmcnt(7)
  s_waitcnt lgkmcnt(2)
  v_mfma_f32_32x32x16_bf16 v[16:31], v[48:51], v[96:99], v[16:31]
  ds_read_b64_tr_b16 v[56:57], v10 offset:36864
  ds_read_b64_tr_b16 v[58:59], v10 offset:37888
  s_add_u32 s73, s68, 32768
  buffer_load_dwordx4 v[64:67], v2, s[48:51], s73 offen offset:0 sc1
  s_waitcnt lgkmcnt(2)
  v_mfma_f32_32x32x16_bf16 v[32:47], v[52:55], v[96:99], v[32:47]
  ds_read_b64_tr_b16 v[60:61], v11 offset:36864
  ds_read_b64_tr_b16 v[62:63], v11 offset:37888
  s_waitcnt vmcnt(7)
  s_waitcnt lgkmcnt(2)
  v_mfma_f32_32x32x16_bf16 v[16:31], v[56:59], v[100:103], v[16:31]
  ds_read_b64_tr_b16 v[48:49], v10 offset:40960
  ds_read_b64_tr_b16 v[50:51], v10 offset:41984
  buffer_load_dwordx4 v[68:71], v2, s[48:51], s73 offen offset:1024 sc1
  s_waitcnt lgkmcnt(2)
  v_mfma_f32_32x32x16_bf16 v[32:47], v[60:63], v[100:103], v[32:47]
  ds_read_b64_tr_b16 v[52:53], v11 offset:40960
  ds_read_b64_tr_b16 v[54:55], v11 offset:41984
  s_waitcnt vmcnt(7)
  s_waitcnt lgkmcnt(2)
  v_mfma_f32_32x32x16_bf16 v[16:31], v[48:51], v[104:107], v[16:31]
  ds_read_b64_tr_b16 v[56:57], v10 offset:45056
  ds_read_b64_tr_b16 v[58:59], v10 offset:46080
  buffer_load_dwordx4 v[72:75], v2, s[48:51], s73 offen offset:2048 sc1
  s_waitcnt lgkmcnt(2)
  v_mfma_f32_32x32x16_bf16 v[32:47], v[52:55], v[104:107], v[32:47]
  ds_read_b64_tr_b16 v[60:61], v11 offset:45056
  ds_read_b64_tr_b16 v[62:63], v11 offset:46080
  s_waitcnt vmcnt(7)
  s_waitcnt lgkmcnt(2)
  v_mfma_f32_32x32x16_bf16 v[16:31], v[56:59], v[108:111], v[16:31]
  ds_read_b64_tr_b16 v[48:49], v10 offset:49152
  ds_read_b64_tr_b16 v[50:51], v10 offset:50176
  buffer_load_dwordx4 v[76:79], v2, s[48:51], s73 offen offset:3072 sc1
  s_waitcnt lgkmcnt(2)
  v_mfma_f32_32x32x16_bf16 v[32:47], v[60:63], v[108:111], v[32:47]
  ds_read_b64_tr_b16 v[52:53], v11 offset:49152
  ds_read_b64_tr_b16 v[54:55], v11 offset:50176
  s_waitcnt vmcnt(7)
  s_waitcnt lgkmcnt(2)
  v_mfma_f32_32x32x16_bf16 v[16:31], v[48:51], v[112:115], v[16:31]
  ds_read_b64_tr_b16 v[56:57], v10 offset:53248
  ds_read_b64_tr_b16 v[58:59], v10 offset:54272
  s_add_u32 s73, s68, 36864
  buffer_load_dwordx4 v[80:83], v2, s[48:51], s73 offen offset:0 sc1
  s_waitcnt lgkmcnt(2)
  v_mfma_f32_32x32x16_bf16 v[32:47], v[52:55], v[112:115], v[32:47]
  ds_read_b64_tr_b16 v[60:61], v11 offset:53248
  ds_read_b64_tr_b16 v[62:63], v11 offset:54272
  s_waitcnt vmcnt(7)
  s_waitcnt lgkmcnt(2)
  v_mfma_f32_32x32x16_bf16 v[16:31], v[56:59], v[116:119], v[16:31]
  ds_read_b64_tr_b16 v[48:49], v10 offset:57344
  ds_read_b64_tr_b16 v[50:51], v10 offset:58368
  buffer_load_dwordx4 v[84:87], v2, s[48:51], s73 offen offset:1024 sc1
  s_waitcnt lgkmcnt(2)
  v_mfma_f32_32x32x16_bf16 v[32:47], v[60:63], v[116:119], v[32:47]
  ds_read_b64_tr_b16 v[52:53], v11 offset:57344
  ds_read_b64_tr_b16 v[54:55], v11 offset:58368
  s_waitcnt vmcnt(7)
  s_waitcnt lgkmcnt(2)
  v_mfma_f32_32x32x16_bf16 v[16:31], v[48:51], v[120:123], v[16:31]
  ds_read_b64_tr_b16 v[56:57], v10 offset:61440
  ds_read_b64_tr_b16 v[58:59], v10 offset:62464
  buffer_load_dwordx4 v[88:91], v2, s[48:51], s73 offen offset:2048 sc1
  s_waitcnt lgkmcnt(2)
  v_mfma_f32_32x32x16_bf16 v[32:47], v[52:55], v[120:123], v[32:47]
  ds_read_b64_tr_b16 v[60:61], v11 offset:61440
  ds_read_b64_tr_b16 v[62:63], v11 offset:62464
  s_waitcnt vmcnt(7)
  s_waitcnt lgkmcnt(2)
  v_mfma_f32_32x32x16_bf16 v[16:31], v[56:59], v[124:127], v[16:31]
  ds_read_b64_tr_b16 v[48:49], v12 offset:0
  ds_read_b64_tr_b16 v[50:51], v12 offset:1024
  buffer_load_dwordx4 v[92:95], v2, s[48:51], s73 offen offset:3072 sc1
  s_waitcnt lgkmcnt(2)
  v_mfma_f32_32x32x16_bf16 v[32:47], v[60:63], v[124:127], v[32:47]
  ds_read_b64_tr_b16 v[52:53], v13 offset:0
  ds_read_b64_tr_b16 v[54:55], v13 offset:1024
  s_waitcnt vmcnt(7)
  s_waitcnt lgkmcnt(2)
  v_mfma_f32_32x32x16_bf16 v[16:31], v[48:51], v[64:67], v[16:31]
  ds_read_b64_tr_b16 v[56:57], v12 offset:4096
  ds_read_b64_tr_b16 v[58:59], v12 offset:5120
  s_add_u32 s73, s68, 40960
  buffer_load_dwordx4 v[96:99], v2, s[48:51], s73 offen offset:0 sc1
  s_waitcnt lgkmcnt(2)
  v_mfma_f32_32x32x16_bf16 v[32:47], v[52:55], v[64:67], v[32:47]
  ds_read_b64_tr_b16 v[60:61], v13 offset:4096
  ds_read_b64_tr_b16 v[62:63], v13 offset:5120
  s_waitcnt vmcnt(7)
  s_waitcnt lgkmcnt(2)
  v_mfma_f32_32x32x16_bf16 v[16:31], v[56:59], v[68:71], v[16:31]
  ds_read_b64_tr_b16 v[48:49], v12 offset:8192
  ds_read_b64_tr_b16 v[50:51], v12 offset:9216
  buffer_load_dwordx4 v[100:103], v2, s[48:51], s73 offen offset:1024 sc1
  s_waitcnt lgkmcnt(2)
  v_mfma_f32_32x32x16_bf16 v[32:47], v[60:63], v[68:71], v[32:47]
  ds_read_b64_tr_b16 v[52:53], v13 offset:8192
  ds_read_b64_tr_b16 v[54:55], v13 offset:9216
  s_waitcnt vmcnt(7)
  s_waitcnt lgkmcnt(2)
  v_mfma_f32_32x32x16_bf16 v[16:31], v[48:51], v[72:75], v[16:31]
  ds_read_b64_tr_b16 v[56:57], v12 offset:12288
  ds_read_b64_tr_b16 v[58:59], v12 offset:13312
  buffer_load_dwordx4 v[104:107], v2, s[48:51], s73 offen offset:2048 sc1
  s_waitcnt lgkmcnt(2)
  v_mfma_f32_32x32x16_bf16 v[32:47], v[52:55], v[72:75], v[32:47]
  ds_read_b64_tr_b16 v[60:61], v13 offset:12288
  ds_read_b64_tr_b16 v[62:63], v13 offset:13312
  s_waitcnt vmcnt(7)
  s_waitcnt lgkmcnt(2)
  v_mfma_f32_32x32x16_bf16 v[16:31], v[56:59], v[76:79], v[16:31]
  ds_read_b64_tr_b16 v[48:49], v12 offset:16384
  ds_read_b64_tr_b16 v[50:51], v12 offset:17408
  buffer_load_dwordx4 v[108:111], v2, s[48:51], s73 offen offset:3072 sc1
  s_waitcnt lgkmcnt(2)
  v_mfma_f32_32x32x16_bf16 v[32:47], v[60:63], v[76:79], v[32:47]
  ds_read_b64_tr_b16 v[52:53], v13 offset:16384
  ds_read_b64_tr_b16 v[54:55], v13 offset:17408
  s_waitcnt vmcnt(7)
  s_waitcnt lgkmcnt(2)
  v_mfma_f32_32x32x16_bf16 v[16:31], v[48:51], v[80:83], v[16:31]
  ds_read_b64_tr_b16 v[56:57], v12 offset:20480
  ds_read_b64_tr_b16 v[58:59], v12 offset:21504
  s_add_u32 s73, s68, 45056
  buffer_load_dwordx4 v[112:115], v2, s[48:51], s73 offen offset:0 sc1
  s_waitcnt lgkmcnt(2)
  v_mfma_f32_32x32x16_bf16 v[32:47], v[52:55], v[80:83], v[32:47]
  ds_read_b64_tr_b16 v[60:61], v13 offset:20480
  ds_read_b64_tr_b16 v[62:63], v13 offset:21504
  s_waitcnt vmcnt(7)
  s_waitcnt lgkmcnt(2)
  v_mfma_f32_32x32x16_bf16 v[16:31], v[56:59], v[84:87], v[16:31]
  ds_read_b64_tr_b16 v[48:49], v12 offset:24576
  ds_read_b64_tr_b16 v[50:51], v12 offset:25600
  buffer_load_dwordx4 v[116:119], v2, s[48:51], s73 offen offset:1024 sc1
  s_waitcnt lgkmcnt(2)
  v_mfma_f32_32x32x16_bf16 v[32:47], v[60:63], v[84:87], v[32:47]
  ds_read_b64_tr_b16 v[52:53], v13 offset:24576
  ds_read_b64_tr_b16 v[54:55], v13 offset:25600
  s_barrier
  s_waitcnt vmcnt(7)
  s_waitcnt lgkmcnt(2)
  v_mfma_f32_32x32x16_bf16 v[16:31], v[48:51], v[88:91], v[16:31]
  ds_read_b64_tr_b16 v[56:57], v12 offset:28672
  ds_read_b64_tr_b16 v[58:59], v12 offset:29696
  buffer_load_dwordx4 v[120:123], v2, s[48:51], s73 offen offset:2048 sc1
  s_waitcnt lgkmcnt(2)
  v_mfma_f32_32x32x16_bf16 v[32:47], v[52:55], v[88:91], v[32:47]
  ds_read_b64_tr_b16 v[60:61], v13 offset:28672
  ds_read_b64_tr_b16 v[62:63], v13 offset:29696
  s_waitcnt vmcnt(7)
  s_waitcnt lgkmcnt(2)
  v_mfma_f32_32x32x16_bf16 v[16:31], v[56:59], v[92:95], v[16:31]
  ds_read_b64_tr_b16 v[48:49], v8 offset:0
  ds_read_b64_tr_b16 v[50:51], v8 offset:1024
  buffer_load_dwordx4 v[124:127], v2, s[48:51], s73 offen offset:3072 sc1
  s_waitcnt lgkmcnt(2)
  v_mfma_f32_32x32x16_bf16 v[32:47], v[60:63], v[92:95], v[32:47]
  ds_read_b64_tr_b16 v[52:53], v9 offset:0
  ds_read_b64_tr_b16 v[54:55], v9 offset:1024
  s_waitcnt vmcnt(7)
  s_waitcnt lgkmcnt(2)
  v_mfma_f32_32x32x16_bf16 v[16:31], v[48:51], v[96:99], v[16:31]
  ds_read_b64_tr_b16 v[56:57], v8 offset:4096
  ds_read_b64_tr_b16 v[58:59], v8 offset:5120
  s_add_u32 s73, s68, 49152
  buffer_load_dwordx4 v[64:67], v2, s[48:51], s73 offen offset:0 sc1
  s_waitcnt lgkmcnt(2)
  v_mfma_f32_32x32x16_bf16 v[32:47], v[52:55], v[96:99], v[32:47]
  ds_read_b64_tr_b16 v[60:61], v9 offset:4096
  ds_read_b64_tr_b16 v[62:63], v9 offset:5120
  s_waitcnt vmcnt(7)
  s_waitcnt lgkmcnt(2)
  v_mfma_f32_32x32x16_bf16 v[16:31], v[56:59], v[100:103], v[16:31]
  ds_read_b64_tr_b16 v[48:49], v8 offset:8192
  ds_read_b64_tr_b16 v[50:51], v8 offset:9216
  buffer_load_dwordx4 v[68:71], v2, s[48:51], s73 offen offset:1024 sc1
  s_waitcnt lgkmcnt(2)
  v_mfma_f32_32x32x16_bf16 v[32:47], v[60:63], v[100:103], v[32:47]
  ds_read_b64_tr_b16 v[52:53], v9 offset:8192
  ds_read_b64_tr_b16 v[54:55], v9 offset:9216
  s_waitcnt vmcnt(7)
  s_waitcnt lgkmcnt(2)
  v_mfma_f32_32x32x16_bf16 v[16:31], v[48:51], v[104:107], v[16:31]
  ds_read_b64_tr_b16 v[56:57], v8 offset:12288
  ds_read_b64_tr_b16 v[58:59], v8 offset:13312
  buffer_load_dwordx4 v[72:75], v2, s[48:51], s73 offen offset:2048 sc1
  s_waitcnt lgkmcnt(2)
  v_mfma_f32_32x32x16_bf16 v[32:47], v[52:55], v[104:107], v[32:47]
  ds_read_b64_tr_b16 v[60:61], v9 offset:12288
  ds_read_b64_tr_b16 v[62:63], v9 offset:13312
  s_waitcnt vmcnt(7)
  s_waitcnt lgkmcnt(2)
  v_mfma_f32_32x32x16_bf16 v[16:31], v[56:59], v[108:111], v[16:31]
  ds_read_b64_tr_b16 v[48:49], v8 offset:16384
  ds_read_b64_tr_b16 v[50:51], v8 offset:17408
  buffer_load_dwordx4 v[76:79], v2, s[48:51], s73 offen offset:3072 sc1
  s_waitcnt lgkmcnt(2)
  v_mfma_f32_32x32x16_bf16 v[32:47], v[60:63], v[108:111], v[32:47]
  ds_read_b64_tr_b16 v[52:53], v9 offset:16384
  ds_read_b64_tr_b16 v[54:55], v9 offset:17408
  s_waitcnt vmcnt(7)
  s_waitcnt lgkmcnt(2)
  v_mfma_f32_32x32x16_bf16 v[16:31], v[48:51], v[112:115], v[16:31]
  ds_read_b64_tr_b16 v[56:57], v8 offset:20480
  ds_read_b64_tr_b16 v[58:59], v8 offset:21504
  s_add_u32 s73, s68, 53248
  buffer_load_dwordx4 v[80:83], v2, s[48:51], s73 offen offset:0 sc1
  s_waitcnt lgkmcnt(2)
  v_mfma_f32_32x32x16_bf16 v[32:47], v[52:55], v[112:115], v[32:47]
  ds_read_b64_tr_b16 v[60:61], v9 offset:20480
  ds_read_b64_tr_b16 v[62:63], v9 offset:21504
  s_waitcnt vmcnt(7)
  s_waitcnt lgkmcnt(2)
  v_mfma_f32_32x32x16_bf16 v[16:31], v[56:59], v[116:119], v[16:31]
  ds_read_b64_tr_b16 v[48:49], v8 offset:24576
  ds_read_b64_tr_b16 v[50:51], v8 offset:25600
  buffer_load_dwordx4 v[84:87], v2, s[48:51], s73 offen offset:1024 sc1
  s_waitcnt lgkmcnt(2)
  v_mfma_f32_32x32x16_bf16 v[32:47], v[60:63], v[116:119], v[32:47]
  ds_read_b64_tr_b16 v[52:53], v9 offset:24576
  ds_read_b64_tr_b16 v[54:55], v9 offset:25600
  s_waitcnt vmcnt(7)
  s_waitcnt lgkmcnt(2)
  v_mfma_f32_32x32x16_bf16 v[16:31], v[48:51], v[120:123], v[16:31]
  ds_read_b64_tr_b16 v[56:57], v8 offset:28672
  ds_read_b64_tr_b16 v[58:59], v8 offset:29696
  buffer_load_dwordx4 v[88:91], v2, s[48:51], s73 offen offset:2048 sc1
  s_waitcnt lgkmcnt(2)
  v_mfma_f32_32x32x16_bf16 v[32:47], v[52:55], v[120:123], v[32:47]
  ds_read_b64_tr_b16 v[60:61], v9 offset:28672
  ds_read_b64_tr_b16 v[62:63], v9 offset:29696
  s_waitcnt vmcnt(7)
  s_waitcnt lgkmcnt(2)
  v_mfma_f32_32x32x16_bf16 v[16:31], v[56:59], v[124:127], v[16:31]
  ds_read_b64_tr_b16 v[48:49], v8 offset:32768
  ds_read_b64_tr_b16 v[50:51], v8 offset:33792
  buffer_load_dwordx4 v[92:95], v2, s[48:51], s73 offen offset:3072 sc1
  s_waitcnt lgkmcnt(2)
  v_mfma_f32_32x32x16_bf16 v[32:47], v[60:63], v[124:127], v[32:47]
  ds_read_b64_tr_b16 v[52:53], v9 offset:32768
  ds_read_b64_tr_b16 v[54:55], v9 offset:33792
  s_waitcnt vmcnt(7)
  s_waitcnt lgkmcnt(2)
  v_mfma_f32_32x32x16_bf16 v[16:31], v[48:51], v[64:67], v[16:31]
  ds_read_b64_tr_b16 v[56:57], v8 offset:36864
  ds_read_b64_tr_b16 v[58:59], v8 offset:37888
  s_waitcnt lgkmcnt(2)
  v_mfma_f32_32x32x16_bf16 v[32:47], v[52:55], v[64:67], v[32:47]
  ds_read_b64_tr_b16 v[60:61], v9 offset:36864
  ds_read_b64_tr_b16 v[62:63], v9 offset:37888
  s_waitcnt vmcnt(6)
  s_waitcnt lgkmcnt(2)
  v_mfma_f32_32x32x16_bf16 v[16:31], v[56:59], v[68:71], v[16:31]
  ds_read_b64_tr_b16 v[48:49], v8 offset:40960
  ds_read_b64_tr_b16 v[50:51], v8 offset:41984
  s_waitcnt lgkmcnt(2)
  v_mfma_f32_32x32x16_bf16 v[32:47], v[60:63], v[68:71], v[32:47]
  ds_read_b64_tr_b16 v[52:53], v9 offset:40960
  ds_read_b64_tr_b16 v[54:55], v9 offset:41984
  s_waitcnt vmcnt(5)
  s_waitcnt lgkmcnt(2)
  v_mfma_f32_32x32x16_bf16 v[16:31], v[48:51], v[72:75], v[16:31]
  ds_read_b64_tr_b16 v[56:57], v8 offset:45056
  ds_read_b64_tr_b16 v[58:59], v8 offset:46080
  s_waitcnt lgkmcnt(2)
  v_mfma_f32_32x32x16_bf16 v[32:47], v[52:55], v[72:75], v[32:47]
  ds_read_b64_tr_b16 v[60:61], v9 offset:45056
  ds_read_b64_tr_b16 v[62:63], v9 offset:46080
  s_waitcnt vmcnt(4)
  s_waitcnt lgkmcnt(2)
  v_mfma_f32_32x32x16_bf16 v[16:31], v[56:59], v[76:79], v[16:31]
  ds_read_b64_tr_b16 v[48:49], v8 offset:49152
  ds_read_b64_tr_b16 v[50:51], v8 offset:50176
  s_waitcnt lgkmcnt(2)
  v_mfma_f32_32x32x16_bf16 v[32:47], v[60:63], v[76:79], v[32:47]
  ds_read_b64_tr_b16 v[52:53], v9 offset:49152
  ds_read_b64_tr_b16 v[54:55], v9 offset:50176
  s_waitcnt vmcnt(3)
  s_waitcnt lgkmcnt(2)
  v_mfma_f32_32x32x16_bf16 v[16:31], v[48:51], v[80:83], v[16:31]
  ds_read_b64_tr_b16 v[56:57], v8 offset:53248
  ds_read_b64_tr_b16 v[58:59], v8 offset:54272
  s_waitcnt lgkmcnt(2)
  v_mfma_f32_32x32x16_bf16 v[32:47], v[52:55], v[80:83], v[32:47]
  ds_read_b64_tr_b16 v[60:61], v9 offset:53248
  ds_read_b64_tr_b16 v[62:63], v9 offset:54272
  s_waitcnt vmcnt(2)
  s_waitcnt lgkmcnt(2)
  v_mfma_f32_32x32x16_bf16 v[16:31], v[56:59], v[84:87], v[16:31]
  ds_read_b64_tr_b16 v[48:49], v8 offset:57344
  ds_read_b64_tr_b16 v[50:51], v8 offset:58368
  s_waitcnt lgkmcnt(2)
  v_mfma_f32_32x32x16_bf16 v[32:47], v[60:63], v[84:87], v[32:47]
  ds_read_b64_tr_b16 v[52:53], v9 offset:57344
  ds_read_b64_tr_b16 v[54:55], v9 offset:58368
  s_waitcnt vmcnt(1)
  s_waitcnt lgkmcnt(2)
  v_mfma_f32_32x32x16_bf16 v[16:31], v[48:51], v[88:91], v[16:31]
  ds_read_b64_tr_b16 v[56:57], v8 offset:61440
  ds_read_b64_tr_b16 v[58:59], v8 offset:62464
  s_waitcnt lgkmcnt(2)
  v_mfma_f32_32x32x16_bf16 v[32:47], v[52:55], v[88:91], v[32:47]
  ds_read_b64_tr_b16 v[60:61], v9 offset:61440
  ds_read_b64_tr_b16 v[62:63], v9 offset:62464
  s_waitcnt vmcnt(0)
  s_waitcnt lgkmcnt(2)
  v_mfma_f32_32x32x16_bf16 v[16:31], v[56:59], v[92:95], v[16:31]
  s_waitcnt lgkmcnt(0)
  v_mfma_f32_32x32x16_bf16 v[32:47], v[60:63], v[92:95], v[32:47]
  s_barrier
  s_nop 10
  ds_write_b128 v15, v[32:35] offset:0
  ds_write_b128 v15, v[36:39] offset:1024
  ds_write_b128 v15, v[40:43] offset:2048
  ds_write_b128 v15, v[44:47] offset:3072
  s_waitcnt lgkmcnt(0)
  s_barrier
  ds_read_b128 v[32:35], v7 offset:0
  ds_read_b128 v[36:39], v7 offset:1024
  ds_read_b128 v[40:43], v7 offset:2048
  ds_read_b128 v[44:47], v7 offset:3072
  s_waitcnt vmcnt(0)
  v_lshlrev_b32 v64, 16, v240
  v_and_b32 v65, 0xffff0000, v240
  v_lshlrev_b32 v66, 16, v241
  v_and_b32 v67, 0xffff0000, v241
  v_lshlrev_b32 v68, 16, v242
  v_and_b32 v69, 0xffff0000, v242
  v_lshlrev_b32 v70, 16, v243
  v_and_b32 v71, 0xffff0000, v243
  v_lshlrev_b32 v72, 16, v244
  v_and_b32 v73, 0xffff0000, v244
  v_lshlrev_b32 v74, 16, v245
  v_and_b32 v75, 0xffff0000, v245
  v_lshlrev_b32 v76, 16, v246
  v_and_b32 v77, 0xffff0000, v246
  v_lshlrev_b32 v78, 16, v247
  v_and_b32 v79, 0xffff0000, v247
  v_add_f32 v16, v16, v64
  v_add_f32 v17, v17, v65
  v_add_f32 v18, v18, v66
  v_add_f32 v19, v19, v67
  v_add_f32 v20, v20, v68
  v_add_f32 v21, v21, v69
  v_add_f32 v22, v22, v70
  v_add_f32 v23, v23, v71
  v_add_f32 v24, v24, v72
  v_add_f32 v25, v25, v73
  v_add_f32 v26, v26, v74
  v_add_f32 v27, v27, v75
  v_add_f32 v28, v28, v76
  v_add_f32 v29, v29, v77
  v_add_f32 v30, v30, v78
  v_add_f32 v31, v31, v79
  s_waitcnt lgkmcnt(0)
  s_barrier
  v_add_f32 v16, v16, v32
  v_add_f32 v17, v17, v33
  v_add_f32 v18, v18, v34
  v_add_f32 v19, v19, v35
  v_add_f32 v20, v20, v36
  v_add_f32 v21, v21, v37
  v_add_f32 v22, v22, v38
  v_add_f32 v23, v23, v39
  v_add_f32 v24, v24, v40
  v_add_f32 v25, v25, v41
  v_add_f32 v26, v26, v42
  v_add_f32 v27, v27, v43
  v_add_f32 v28, v28, v44
  v_add_f32 v29, v29, v45
  v_add_f32 v30, v30, v46
  v_add_f32 v31, v31, v47
  v_cvt_pk_bf16_f32 v80, v16, v17
  v_cvt_pk_bf16_f32 v81, v18, v19
  v_cvt_pk_bf16_f32 v82, v20, v21
  v_cvt_pk_bf16_f32 v83, v22, v23
  v_cvt_pk_bf16_f32 v84, v24, v25
  v_cvt_pk_bf16_f32 v85, v26, v27
  v_cvt_pk_bf16_f32 v86, v28, v29
  v_cvt_pk_bf16_f32 v87, v30, v31
  v_permlane32_swap_b32 v80, v82
  v_permlane32_swap_b32 v81, v83
  buffer_store_dwordx4 v[80:83], v14, s[40:43], s71 offen offset:0
  v_permlane32_swap_b32 v84, v86
  v_permlane32_swap_b32 v85, v87
  buffer_store_dwordx4 v[84:87], v14, s[40:43], s71 offen offset:32
  s_nop 1
  s_branch L_p5_done
L_p5_helper:
  s_mov_b32 s44, s28
  s_and_b32 s45, s29, 0xffff
  s_mov_b32 s46, 0x1c0000
  s_mov_b32 s47, 0x20000
  s_and_b32 s79, s39, 7
  s_lshl_b32 s58, s37, 3
  s_add_u32 s58, s58, s79
  s_lshr_b32 s79, s39, 3
  s_lshl_b32 s59, s38, 2
  s_add_u32 s59, s59, s79
  s_lshl_b32 s58, s59, 7
  v_lshrrev_b32 v4, 3, v1
  v_and_b32 v5, 7, v1
  v_lshlrev_b32 v6, 1, v4
  v_and_b32 v6, 4, v6
  v_xor_b32 v5, v5, v6
  v_lshlrev_b32 v5, 4, v5
  s_mov_b32 s79, 1024
  v_mul_lo_u32 v3, v4, s79
  v_add_u32 v3, v3, v5
  s_and_b32 s76, s57, 1
  s_lshr_b32 s78, s57, 1
  s_lshl_b32 s78, s78, 3
  s_mul_i32 s59, s76, 917504
  s_add_u32 s59, s59, s58
  s_lshl_b32 s77, s78, 14
  s_add_u32 s59, s59, s77
  s_lshl_b32 s77, s76, 11
  s_lshl_b32 s78, s78, 12
  s_add_u32 s77, s77, s78
  s_add_u32 s79, s59, 393216
  s_add_u32 m0, s77, 98304
  s_nop 0
  buffer_load_dwordx4 v3, s[44:47], s79 offen lds
  s_add_u32 s79, s59, 401408
  s_add_u32 m0, s77, 99328
  s_nop 0
  buffer_load_dwordx4 v3, s[44:47], s79 offen lds
  s_add_u32 s79, s59, 409600
  s_add_u32 m0, s77, 102400
  s_nop 0
  buffer_load_dwordx4 v3, s[44:47], s79 offen lds
  s_add_u32 s79, s59, 417792
  s_add_u32 m0, s77, 103424
  s_nop 0
  buffer_load_dwordx4 v3, s[44:47], s79 offen lds
  s_add_u32 s79, s59, 425984
  s_add_u32 m0, s77, 106496
  s_nop 0
  buffer_load_dwordx4 v3, s[44:47], s79 offen lds
  s_add_u32 s79, s59, 434176
  s_add_u32 m0, s77, 107520
  s_nop 0
  buffer_load_dwordx4 v3, s[44:47], s79 offen lds
  s_add_u32 s79, s59, 442368
  s_add_u32 m0, s77, 110592
  s_nop 0
  buffer_load_dwordx4 v3, s[44:47], s79 offen lds
  s_add_u32 s79, s59, 450560
  s_add_u32 m0, s77, 111616
  s_nop 0
  buffer_load_dwordx4 v3, s[44:47], s79 offen lds
  s_add_u32 s79, s59, 458752
  s_add_u32 m0, s77, 114688
  s_nop 0
  buffer_load_dwordx4 v3, s[44:47], s79 offen lds
  s_add_u32 s79, s59, 466944
  s_add_u32 m0, s77, 115712
  s_nop 0
  buffer_load_dwordx4 v3, s[44:47], s79 offen lds
  s_add_u32 s79, s59, 475136
  s_add_u32 m0, s77, 118784
  s_nop 0
  buffer_load_dwordx4 v3, s[44:47], s79 offen lds
  s_add_u32 s79, s59, 483328
  s_add_u32 m0, s77, 119808
  s_nop 0
  buffer_load_dwordx4 v3, s[44:47], s79 offen lds
  s_add_u32 s79, s59, 491520
  s_add_u32 m0, s77, 122880
  s_nop 0
  buffer_load_dwordx4 v3, s[44:47], s79 offen lds
  s_add_u32 s79, s59, 499712
  s_add_u32 m0, s77, 123904
  s_nop 0
  buffer_load_dwordx4 v3, s[44:47], s79 offen lds
  s_add_u32 s79, s59, 507904
  s_add_u32 m0, s77, 126976
  s_nop 0
  buffer_load_dwordx4 v3, s[44:47], s79 offen lds
  s_add_u32 s79, s59, 516096
  s_add_u32 m0, s77, 128000
  s_nop 0
  buffer_load_dwordx4 v3, s[44:47], s79 offen lds
  s_add_u32 s79, s59, 655360
  buffer_load_dwordx4 v[32:35], v3, s[44:47], s79 offen
  s_add_u32 s79, s59, 663552
  buffer_load_dwordx4 v[36:39], v3, s[44:47], s79 offen
  s_add_u32 s79, s59, 671744
  buffer_load_dwordx4 v[40:43], v3, s[44:47], s79 offen
  s_add_u32 s79, s59, 679936
  buffer_load_dwordx4 v[44:47], v3, s[44:47], s79 offen
  s_add_u32 s79, s59, 688128
  buffer_load_dwordx4 v[48:51], v3, s[44:47], s79 offen
  s_add_u32 s79, s59, 696320
  buffer_load_dwordx4 v[52:55], v3, s[44:47], s79 offen
  s_add_u32 s79, s59, 704512
  buffer_load_dwordx4 v[56:59], v3, s[44:47], s79 offen
  s_add_u32 s79, s59, 712704
  buffer_load_dwordx4 v[60:63], v3, s[44:47], s79 offen
  s_add_u32 s79, s59, 720896
  buffer_load_dwordx4 v[64:67], v3, s[44:47], s79 offen
  s_add_u32 s79, s59, 729088
  buffer_load_dwordx4 v[68:71], v3, s[44:47], s79 offen
  s_add_u32 s79, s59, 737280
  buffer_load_dwordx4 v[72:75], v3, s[44:47], s79 offen
  s_add_u32 s79, s59, 745472
  buffer_load_dwordx4 v[76:79], v3, s[44:47], s79 offen
  s_add_u32 s79, s59, 753664
  buffer_load_dwordx4 v[80:83], v3, s[44:47], s79 offen
  s_add_u32 s79, s59, 761856
  buffer_load_dwordx4 v[84:87], v3, s[44:47], s79 offen
  s_add_u32 s79, s59, 770048
  buffer_load_dwordx4 v[88:91], v3, s[44:47], s79 offen
  s_add_u32 s79, s59, 778240
  buffer_load_dwordx4 v[92:95], v3, s[44:47], s79 offen
  v_add_u32 v4, s77, v2
  s_waitcnt vmcnt(16)
  s_barrier
  s_waitcnt vmcnt(0)
  ds_write_b128 v4, v[32:35] offset:0
  ds_write_b128 v4, v[36:39] offset:1024
  ds_write_b128 v4, v[40:43] offset:4096
  ds_write_b128 v4, v[44:47] offset:5120
  ds_write_b128 v4, v[48:51] offset:8192
  ds_write_b128 v4, v[52:55] offset:9216
  ds_write_b128 v4, v[56:59] offset:12288
  ds_write_b128 v4, v[60:63] offset:13312
  ds_write_b128 v4, v[64:67] offset:16384
  ds_write_b128 v4, v[68:71] offset:17408
  ds_write_b128 v4, v[72:75] offset:20480
  ds_write_b128 v4, v[76:79] offset:21504
  ds_write_b128 v4, v[80:83] offset:24576
  ds_write_b128 v4, v[84:87] offset:25600
  ds_write_b128 v4, v[88:91] offset:28672
  ds_write_b128 v4, v[92:95] offset:29696
  s_waitcnt lgkmcnt(0)
  s_barrier
  s_barrier
  s_barrier
  s_barrier
L_p5_done:
L_end_sequential_preLN__sliding_block__geglu_ffn__prompt_kernel:
  s_endpgm
L_code_end:
  s_nop 0
.section .rodata,"a"
.p2align 6
.amdhsa_kernel sequential_preLN__sliding_block__geglu_ffn__prompt_kernel
  .amdhsa_next_free_vgpr 256
  .amdhsa_next_free_sgpr 102
  .amdhsa_accum_offset 256
  .amdhsa_group_segment_fixed_size 0
  .amdhsa_kernarg_size 80
  .amdhsa_user_sgpr_count 2
  .amdhsa_user_sgpr_kernarg_segment_ptr 1
  .amdhsa_system_sgpr_workgroup_id_x 1
.end_amdhsa_kernel
```
